```python
import torch

def _softmax(x, axis=-1):
    return torch.softmax(x, dim=axis)
def _gelu(x):
    return torch.nn.functional.gelu(x, approximate="tanh")
def _silu(x):
    return torch.nn.functional.silu(x)
def _sigmoid(x):
    return torch.sigmoid(x)
def _layernorm(x, axis=-1, eps=1e-5):
    m = x.mean(dim=axis, keepdim=True)
    v = x.var(dim=axis, keepdim=True, unbiased=False)
    return (x - m) / torch.sqrt(v + eps)
def _scatter_add(tgt, idx, src, axis=0):
    return tgt.clone().index_add_(axis, idx, src)
def _segment_sum(src, seg, n):
    out = torch.zeros((n,) + src.shape[1:], dtype=src.dtype)
    return out.index_add_(0, seg, src)
def _pad(x, pw):
    flat = tuple(v for pair in reversed(pw) for v in pair)
    return torch.nn.functional.pad(x, flat)

kernel_name = 'concat_heads__ssm_conv_s4__grouped_kv_mqa__prompt'

def setup_inputs():

    _w = (lambda a: (lambda t: t.to(torch.bfloat16) if t.is_floating_point() else t)(torch.as_tensor(a)))
    def _A_setup():
        B, L, D, N = 1, 2048, 576, 128
        A_re = -(lambda _x: torch.exp(torch.as_tensor(_x)))((lambda *s: torch.randn(*s, dtype=torch.bfloat16) * 3.2)(D, N))
        A_im = torch.pi * (lambda *s: torch.randn(*s, dtype=torch.bfloat16) * 0.05)(D, N)
        B_re = (lambda *s: torch.randn(*s, dtype=torch.bfloat16) * 0.1)(D, N)
        B_im = (lambda *s: torch.randn(*s, dtype=torch.bfloat16) * 0.1)(D, N)
        C_re = (lambda *s: torch.randn(*s, dtype=torch.bfloat16) * 0.1)(D, N)
        C_im = (lambda *s: torch.randn(*s, dtype=torch.bfloat16) * 0.1)(D, N)
        log_dt = (lambda *s: torch.randn(*s, dtype=torch.bfloat16) * 0.05)(D) * 0.5 - 4.0
        Dskip = (lambda *s: torch.randn(*s, dtype=torch.bfloat16) * 0.05)(D)
        return {
            "u": _w((lambda *s: torch.randn(*s, dtype=torch.bfloat16) * 0.05)(B, L, D)),
            "A_re": _w(A_re),
            "A_im": _w(A_im),
            "B_re": _w(B_re),
            "B_im": _w(B_im),
            "C_re": _w(C_re),
            "C_im": _w(C_im),
            "log_dt": _w(log_dt),
            "Dskip": _w(Dskip),
        }
    _A_in = _A_setup()

    def _B_setup():
        B, S, D, H = 1, 2048, 576, 32
        Dh = D // H
        return {
            "x": _w((lambda *s: torch.randn(*s, dtype=torch.bfloat16) * 0.05)(B, S, D)),
            "wq": _w((lambda *s: torch.randn(*s, dtype=torch.bfloat16) * 0.8)(D, H * Dh)),
            "wk": _w((lambda *s: torch.randn(*s, dtype=torch.bfloat16) * 0.8)(D, Dh)),
            "wv": _w((lambda *s: torch.randn(*s, dtype=torch.bfloat16) * 0.05)(D, Dh)),
            "wo": _w((lambda *s: torch.randn(*s, dtype=torch.bfloat16) * 0.05)(H * Dh, D)),
        }
    _B_in = _B_setup()

    return {
        "A_u": _A_in["u"],
        "A_A_re": _A_in["A_re"],
        "A_A_im": _A_in["A_im"],
        "A_B_re": _A_in["B_re"],
        "A_B_im": _A_in["B_im"],
        "A_C_re": _A_in["C_re"],
        "A_C_im": _A_in["C_im"],
        "A_log_dt": _A_in["log_dt"],
        "A_Dskip": _A_in["Dskip"],
        "B_x": _B_in["x"],
        "B_wq": _B_in["wq"],
        "B_wk": _B_in["wk"],
        "B_wv": _B_in["wv"],
        "B_wo": _B_in["wo"],
    }

def reference(A_u, A_A_re, A_A_im, A_B_re, A_B_im, A_C_re, A_C_im, A_log_dt, A_Dskip, B_x, B_wq, B_wk, B_wv, B_wo):
    def _A_ref(u, A_re, A_im, B_re, B_im, C_re, C_im, log_dt, Dskip):
        Bsz, L, D = u.shape
        dt = torch.exp(log_dt)[:, None]
        A = A_re + 1j * A_im
        Bc = B_re + 1j * B_im
        Cc = C_re + 1j * C_im
        logdA = dt * A
        dB = dt * Bc
        l = (lambda x, dt: x.to(dt))(torch.arange(L), A_re.dtype)
        P = torch.exp(logdA[:, :, None] * l[None, None, :])
        K = torch.einsum("dn,dnl,dn->dl", Cc, P, dB).real
        L2 = 2 * L
        Kp = _pad(K, ((0, 0), (0, L)))
        up = (lambda x, *d: x.permute(*d))(u, 0, 2, 1)
        up = _pad(up, ((0, 0), (0, 0), (0, L)))
        Kf = (lambda x, axes=(-2,-1): torch.fft.rfft2(x.float(), dim=axes))(Kp[:, None, :], axes=(-2, -1))
        Uf = (lambda x, axes=(-2,-1): torch.fft.rfft2(x.float(), dim=axes))(up[:, :, None, :], axes=(-2, -1))
        Yf = Uf * Kf[None, :, :, :]
        y = (lambda x, s, axes=(-2,-1): torch.fft.irfft2(x, s=s, dim=axes).to(torch.bfloat16))(Yf, (1, L2), axes=(-2, -1))[:, :, 0, :L]
        y = (lambda x, *d: x.permute(*d))(y, 0, 2, 1) + u * Dskip[None, None, :]
        return y

    def _B_ref(x, wq, wk, wv, wo):
        B, S, D = x.shape
        H = 32
        Dh = D // H
        q = (lambda x, *d: x.permute(*d))((x @ wq).reshape(B, S, H, Dh), 0, 2, 1, 3)
        k = x @ wk
        v = x @ wv
        scores = torch.einsum("bhqd,bkd->bhqk", q, k) * (Dh ** -0.5)
        p = _softmax(scores, axis=-1)
        o = torch.einsum("bhqk,bkd->bhqd", p, v)
        return (lambda x, *d: x.permute(*d))(o, 0, 2, 1, 3).reshape(B, S, H * Dh) @ wo

    a = _A_ref(A_u, A_A_re, A_A_im, A_B_re, A_B_im, A_C_re, A_C_im, A_log_dt, A_Dskip)
    b = _B_ref(B_x, B_wq, B_wk, B_wv, B_wo)
    return torch.concatenate([a, b], axis=-1)
```

```asm
; @launch kernel=k2_kernel grid=(512,1,1) block=(320,1,1) lds=81920
.amdgcn_target "amdgcn-amd-amdhsa--gfx950"
.text
.globl k2_kernel
.p2align 8
.type k2_kernel,@function
k2_kernel:
  s_load_dwordx2 s[12:13], s[0:1], 128
  s_load_dwordx2 s[14:15], s[0:1], 120
  s_load_dwordx8 s[88:95], s[0:1], 72
  s_load_dwordx2 s[60:61], s[0:1], 0
  s_load_dwordx2 s[62:63], s[0:1], 112
  s_cmp_ge_u32 s2, 512
  s_cbranch_scc1 L_end_k2_kernel
  v_lshrrev_b32 v1, 6, v0
  v_and_b32 v2, 63, v0
  s_nop 0
  v_readfirstlane_b32 s20, v1
  s_xor_b32 s2, s2, 256
  s_cmp_ge_u32 s2, 256
  s_cbranch_scc1 L_conv
  s_cmp_eq_u32 s20, 4
  s_cbranch_scc1 L_loader
  s_waitcnt lgkmcnt(0)
  s_mov_b32 s56, s88
  s_and_b32 s57, s89, 0xffff
  s_mov_b32 s58, 2359296
  s_mov_b32 s59, 0x00020000
  s_mov_b32 s60, s90
  s_and_b32 s61, s91, 0xffff
  s_mov_b32 s62, 663552
  s_mov_b32 s63, 0x00020000
  s_setprio 3
  s_and_b32 s21, s2, 7
  s_lshl_b32 s21, s21, 3
  s_lshr_b32 s3, s2, 5
  s_add_u32 s21, s21, s3
  s_bfe_u32 s22, s2, 0x20003
  s_mul_i32 s28, s22, 288
  s_and_b32 s33, s28, 32
  s_andn2_b32 s28, s28, 63
  s_lshl_b32 s26, s22, 1
  s_add_u32 s26, s26, s3
  s_sub_u32 s3, s26, 9
  s_cmp_ge_u32 s26, 9
  s_cselect_b32 s26, s3, s26
  s_mov_b32 s27, s26
  s_lshl_b32 s24, s20, 10
  s_add_u32 s3, s20, 0
  s_lshl_b32 s3, s3, 6
  v_add_u32 v8, s3, v2
  v_mul_u32_u24 v9, 3277, v8
  v_lshrrev_b32 v9, 16, v9
  v_mul_u32_u24 v10, 20, v9
  v_sub_u32 v10, v8, v10
  v_and_b32 v8, 4, v9
  v_lshrrev_b32 v11, 1, v8
  v_xor_b32 v10, v10, v11
  v_lshlrev_b32 v8, 1, v8
  v_and_b32 v11, 8, v9
  v_lshrrev_b32 v11, 1, v11
  v_and_b32 v9, 0xfffffff3, v9
  v_or3_b32 v9, v9, v8, v11
  v_mul_u32_u24 v4, 1152, v9
  v_lshl_add_u32 v4, v10, 4, v4
  v_add_u32 v4, s28, v4
  s_add_u32 s3, s20, 5
  s_lshl_b32 s3, s3, 6
  v_add_u32 v8, s3, v2
  v_mul_u32_u24 v9, 3277, v8
  v_lshrrev_b32 v9, 16, v9
  v_mul_u32_u24 v10, 20, v9
  v_sub_u32 v10, v8, v10
  v_and_b32 v8, 4, v9
  v_lshrrev_b32 v11, 1, v8
  v_xor_b32 v10, v10, v11
  v_lshlrev_b32 v8, 1, v8
  v_and_b32 v11, 8, v9
  v_lshrrev_b32 v11, 1, v11
  v_and_b32 v9, 0xfffffff3, v9
  v_or3_b32 v9, v9, v8, v11
  v_mul_u32_u24 v5, 1152, v9
  v_lshl_add_u32 v5, v10, 4, v5
  v_add_u32 v5, s28, v5
  v_lshrrev_b32 v8, 3, v2
  v_and_b32 v9, 7, v2
  s_lshl_b32 s3, s21, 5
  s_lshl_b32 s25, s20, 3
  s_add_u32 s3, s3, s25
  v_add_u32 v10, s3, v8
  v_mul_u32_u24 v6, 1152, v10
  s_lshl_b32 s25, s20, 2
  v_lshrrev_b32 v10, 1, v8
  v_add_u32 v10, s25, v10
  v_and_b32 v10, 7, v10
  v_xor_b32 v10, v10, v9
  v_lshl_add_u32 v6, v10, 4, v6
  s_lshl_b32 s25, s27, 7
  s_add_u32 m0, s24, 64512
  s_add_u32 s27, s27, 1
  s_cmp_eq_u32 s27, 9
  s_cselect_b32 s27, 0, s27
  buffer_load_dwordx4 v6, s[56:59], s25 offen lds
  s_mul_i32 s29, s26, 73728
  s_add_u32 m0, s24, 0
  s_nop 0
  buffer_load_dwordx4 v4, s[60:63], s29 offen lds
  s_add_u32 m0, s24, 5120
  s_nop 0
  buffer_load_dwordx4 v5, s[60:63], s29 offen lds
  s_add_u32 s29, s29, 36864
  s_add_u32 s26, s26, 1
  s_cmp_eq_u32 s26, 9
  s_cselect_b32 s26, 0, s26
  s_add_u32 m0, s24, 10240
  s_nop 0
  buffer_load_dwordx4 v4, s[60:63], s29 offen lds
  s_add_u32 m0, s24, 15360
  s_nop 0
  buffer_load_dwordx4 v5, s[60:63], s29 offen lds
  s_lshl_b32 s25, s27, 7
  s_add_u32 m0, s24, 68608
  s_add_u32 s27, s27, 1
  s_cmp_eq_u32 s27, 9
  s_cselect_b32 s27, 0, s27
  buffer_load_dwordx4 v6, s[56:59], s25 offen lds
  s_mul_i32 s29, s26, 73728
  s_add_u32 m0, s24, 20480
  s_nop 0
  buffer_load_dwordx4 v4, s[60:63], s29 offen lds
  s_add_u32 m0, s24, 25600
  s_nop 0
  buffer_load_dwordx4 v5, s[60:63], s29 offen lds
  s_add_u32 s29, s29, 36864
  s_add_u32 s26, s26, 1
  s_cmp_eq_u32 s26, 9
  s_cselect_b32 s26, 0, s26
  s_add_u32 m0, s24, 30720
  s_nop 0
  buffer_load_dwordx4 v4, s[60:63], s29 offen lds
  s_add_u32 m0, s24, 35840
  s_nop 0
  buffer_load_dwordx4 v5, s[60:63], s29 offen lds
  s_lshl_b32 s25, s27, 7
  s_add_u32 m0, s24, 72704
  s_add_u32 s27, s27, 1
  s_cmp_eq_u32 s27, 9
  s_cselect_b32 s27, 0, s27
  buffer_load_dwordx4 v6, s[56:59], s25 offen lds
  s_mul_i32 s29, s26, 73728
  s_add_u32 m0, s24, 40960
  s_nop 0
  buffer_load_dwordx4 v4, s[60:63], s29 offen lds
  s_add_u32 m0, s24, 46080
  s_nop 0
  buffer_load_dwordx4 v5, s[60:63], s29 offen lds
  s_add_u32 s29, s29, 36864
  s_add_u32 s26, s26, 1
  s_cmp_eq_u32 s26, 9
  s_cselect_b32 s26, 0, s26
  s_add_u32 m0, s24, 51200
  s_nop 0
  buffer_load_dwordx4 v4, s[60:63], s29 offen lds
  s_add_u32 m0, s24, 56320
  s_nop 0
  buffer_load_dwordx4 v5, s[60:63], s29 offen lds
  s_lshl_b32 s25, s27, 7
  s_add_u32 m0, s24, 76800
  s_add_u32 s27, s27, 1
  s_cmp_eq_u32 s27, 9
  s_cselect_b32 s27, 0, s27
  buffer_load_dwordx4 v6, s[56:59], s25 offen lds
  v_and_b32 v113, 15, v2
  v_lshrrev_b32 v114, 4, v2
  v_lshrrev_b32 v13, 1, v113
  v_xor_b32 v13, v13, v114
  v_lshlrev_b32 v13, 4, v13
  v_lshl_add_u32 v108, v113, 7, v13
  v_xor_b32 v109, 64, v108
  s_and_b32 s23, s20, 1
  s_lshl_b32 s3, s23, 11
  s_add_u32 s3, s3, 64512
  v_add_u32 v110, s3, v108
  v_add_u32 v111, s3, v109
  s_xor_b32 s3, s23, 1
  s_lshl_b32 s3, s3, 11
  s_add_u32 s3, s3, 64512
  v_add_u32 v108, s3, v108
  v_add_u32 v109, s3, v109
  v_lshrrev_b32 v9, 5, v2
  v_lshlrev_b32 v9, 4, v9
  v_and_b32 v10, 1, v114
  v_lshl_add_u32 v9, v10, 2, v9
  v_lshrrev_b32 v10, 2, v113
  v_add_u32 v9, v9, v10
  v_mul_u32_u24 v9, 320, v9
  v_and_b32 v10, 3, v2
  v_lshl_add_u32 v9, v10, 3, v9
  v_and_b32 v10, 1, v114
  v_lshlrev_b32 v10, 5, v10
  s_lshl_b32 s3, s20, 6
  s_add_u32 s3, s3, s33
  v_xor_b32 v112, s3, v10
  v_add_u32 v112, v112, v9
  s_add_u32 s3, s3, 32
  v_xor_b32 v15, s3, v10
  v_add_u32 v15, v15, v9
  s_add_u32 s3, s33, 256
  v_xor_b32 v14, s3, v10
  v_add_u32 v14, v14, v9
  s_waitcnt vmcnt(11)
  s_barrier
  ds_read_b128 v[16:19], v110 offset:0
  ds_read_b128 v[20:23], v108 offset:0
  ds_read_b64_tr_b16 v[64:65], v112 offset:0
  ds_read_b64_tr_b16 v[66:67], v112 offset:2560
  ds_read_b64_tr_b16 v[68:69], v15 offset:0
  ds_read_b64_tr_b16 v[70:71], v15 offset:2560
  ds_read_b64_tr_b16 v[72:73], v14 offset:0
  ds_read_b64_tr_b16 v[74:75], v14 offset:2560
  s_waitcnt lgkmcnt(7)
  ds_read_b128 v[24:27], v111 offset:0
  ds_read_b128 v[28:31], v109 offset:0
  ds_read_b64_tr_b16 v[76:77], v112 offset:10240
  ds_read_b64_tr_b16 v[78:79], v112 offset:12800
  ds_read_b64_tr_b16 v[80:81], v15 offset:10240
  ds_read_b64_tr_b16 v[82:83], v15 offset:12800
  ds_read_b64_tr_b16 v[84:85], v14 offset:10240
  ds_read_b64_tr_b16 v[86:87], v14 offset:12800
  s_waitcnt lgkmcnt(8)
  v_mfma_f32_16x16x32_bf16 v[88:91], v[64:67], v[16:19], 0
  v_mfma_f32_16x16x32_bf16 v[92:95], v[64:67], v[20:23], 0
  v_mfma_f32_16x16x32_bf16 v[96:99], v[68:71], v[16:19], 0
  v_mfma_f32_16x16x32_bf16 v[100:103], v[68:71], v[20:23], 0
  v_mfma_f32_16x16x32_bf16 v[104:107], v[72:75], v[16:19], 0
  s_waitcnt lgkmcnt(0)
  v_mfma_f32_16x16x32_bf16 v[88:91], v[76:79], v[24:27], v[88:91]
  v_mfma_f32_16x16x32_bf16 v[92:95], v[76:79], v[28:31], v[92:95]
  v_mfma_f32_16x16x32_bf16 v[96:99], v[80:83], v[24:27], v[96:99]
  v_mfma_f32_16x16x32_bf16 v[100:103], v[80:83], v[28:31], v[100:103]
  v_mfma_f32_16x16x32_bf16 v[104:107], v[84:87], v[24:27], v[104:107]
  s_waitcnt vmcnt(6)
  s_barrier
  ds_read_b128 v[16:19], v110 offset:4096
  ds_read_b128 v[20:23], v108 offset:4096
  ds_read_b64_tr_b16 v[64:65], v112 offset:20480
  ds_read_b64_tr_b16 v[66:67], v112 offset:23040
  ds_read_b64_tr_b16 v[68:69], v15 offset:20480
  ds_read_b64_tr_b16 v[70:71], v15 offset:23040
  ds_read_b64_tr_b16 v[72:73], v14 offset:20480
  ds_read_b64_tr_b16 v[74:75], v14 offset:23040
  s_waitcnt lgkmcnt(7)
  ds_read_b128 v[24:27], v111 offset:4096
  ds_read_b128 v[28:31], v109 offset:4096
  ds_read_b64_tr_b16 v[76:77], v112 offset:30720
  ds_read_b64_tr_b16 v[78:79], v112 offset:33280
  ds_read_b64_tr_b16 v[80:81], v15 offset:30720
  ds_read_b64_tr_b16 v[82:83], v15 offset:33280
  ds_read_b64_tr_b16 v[84:85], v14 offset:30720
  ds_read_b64_tr_b16 v[86:87], v14 offset:33280
  s_mul_i32 s29, s26, 73728
  s_add_u32 m0, s24, 0
  s_nop 0
  buffer_load_dwordx4 v4, s[60:63], s29 offen lds
  s_add_u32 m0, s24, 5120
  s_nop 0
  buffer_load_dwordx4 v5, s[60:63], s29 offen lds
  s_add_u32 s29, s29, 36864
  s_add_u32 s26, s26, 1
  s_cmp_eq_u32 s26, 9
  s_cselect_b32 s26, 0, s26
  s_add_u32 m0, s24, 10240
  s_nop 0
  buffer_load_dwordx4 v4, s[60:63], s29 offen lds
  s_add_u32 m0, s24, 15360
  s_nop 0
  buffer_load_dwordx4 v5, s[60:63], s29 offen lds
  s_lshl_b32 s25, s27, 7
  s_add_u32 m0, s24, 64512
  s_add_u32 s27, s27, 1
  s_cmp_eq_u32 s27, 9
  s_cselect_b32 s27, 0, s27
  buffer_load_dwordx4 v6, s[56:59], s25 offen lds
  s_waitcnt lgkmcnt(8)
  v_mfma_f32_16x16x32_bf16 v[88:91], v[64:67], v[16:19], v[88:91]
  v_mfma_f32_16x16x32_bf16 v[92:95], v[64:67], v[20:23], v[92:95]
  v_mfma_f32_16x16x32_bf16 v[96:99], v[68:71], v[16:19], v[96:99]
  v_mfma_f32_16x16x32_bf16 v[100:103], v[68:71], v[20:23], v[100:103]
  v_mfma_f32_16x16x32_bf16 v[104:107], v[72:75], v[16:19], v[104:107]
  s_waitcnt lgkmcnt(0)
  v_mfma_f32_16x16x32_bf16 v[88:91], v[76:79], v[24:27], v[88:91]
  v_mfma_f32_16x16x32_bf16 v[92:95], v[76:79], v[28:31], v[92:95]
  v_mfma_f32_16x16x32_bf16 v[96:99], v[80:83], v[24:27], v[96:99]
  v_mfma_f32_16x16x32_bf16 v[100:103], v[80:83], v[28:31], v[100:103]
  v_mfma_f32_16x16x32_bf16 v[104:107], v[84:87], v[24:27], v[104:107]
  s_waitcnt vmcnt(6)
  s_barrier
  ds_read_b128 v[16:19], v110 offset:8192
  ds_read_b128 v[20:23], v108 offset:8192
  ds_read_b64_tr_b16 v[64:65], v112 offset:40960
  ds_read_b64_tr_b16 v[66:67], v112 offset:43520
  ds_read_b64_tr_b16 v[68:69], v15 offset:40960
  ds_read_b64_tr_b16 v[70:71], v15 offset:43520
  ds_read_b64_tr_b16 v[72:73], v14 offset:40960
  ds_read_b64_tr_b16 v[74:75], v14 offset:43520
  s_waitcnt lgkmcnt(7)
  ds_read_b128 v[24:27], v111 offset:8192
  ds_read_b128 v[28:31], v109 offset:8192
  ds_read_b64_tr_b16 v[76:77], v112 offset:51200
  ds_read_b64_tr_b16 v[78:79], v112 offset:53760
  ds_read_b64_tr_b16 v[80:81], v15 offset:51200
  ds_read_b64_tr_b16 v[82:83], v15 offset:53760
  ds_read_b64_tr_b16 v[84:85], v14 offset:51200
  ds_read_b64_tr_b16 v[86:87], v14 offset:53760
  s_mul_i32 s29, s26, 73728
  s_add_u32 m0, s24, 20480
  s_nop 0
  buffer_load_dwordx4 v4, s[60:63], s29 offen lds
  s_add_u32 m0, s24, 25600
  s_nop 0
  buffer_load_dwordx4 v5, s[60:63], s29 offen lds
  s_add_u32 s29, s29, 36864
  s_add_u32 s26, s26, 1
  s_cmp_eq_u32 s26, 9
  s_cselect_b32 s26, 0, s26
  s_add_u32 m0, s24, 30720
  s_nop 0
  buffer_load_dwordx4 v4, s[60:63], s29 offen lds
  s_add_u32 m0, s24, 35840
  s_nop 0
  buffer_load_dwordx4 v5, s[60:63], s29 offen lds
  s_lshl_b32 s25, s27, 7
  s_add_u32 m0, s24, 68608
  s_add_u32 s27, s27, 1
  s_cmp_eq_u32 s27, 9
  s_cselect_b32 s27, 0, s27
  buffer_load_dwordx4 v6, s[56:59], s25 offen lds
  s_waitcnt lgkmcnt(8)
  v_mfma_f32_16x16x32_bf16 v[88:91], v[64:67], v[16:19], v[88:91]
  v_mfma_f32_16x16x32_bf16 v[92:95], v[64:67], v[20:23], v[92:95]
  v_mfma_f32_16x16x32_bf16 v[96:99], v[68:71], v[16:19], v[96:99]
  v_mfma_f32_16x16x32_bf16 v[100:103], v[68:71], v[20:23], v[100:103]
  v_mfma_f32_16x16x32_bf16 v[104:107], v[72:75], v[16:19], v[104:107]
  s_waitcnt lgkmcnt(0)
  v_mfma_f32_16x16x32_bf16 v[88:91], v[76:79], v[24:27], v[88:91]
  v_mfma_f32_16x16x32_bf16 v[92:95], v[76:79], v[28:31], v[92:95]
  v_mfma_f32_16x16x32_bf16 v[96:99], v[80:83], v[24:27], v[96:99]
  v_mfma_f32_16x16x32_bf16 v[100:103], v[80:83], v[28:31], v[100:103]
  v_mfma_f32_16x16x32_bf16 v[104:107], v[84:87], v[24:27], v[104:107]
  s_waitcnt vmcnt(6)
  s_barrier
  ds_read_b128 v[16:19], v110 offset:12288
  ds_read_b128 v[20:23], v108 offset:12288
  ds_read_b64_tr_b16 v[64:65], v112 offset:0
  ds_read_b64_tr_b16 v[66:67], v112 offset:2560
  ds_read_b64_tr_b16 v[68:69], v15 offset:0
  ds_read_b64_tr_b16 v[70:71], v15 offset:2560
  ds_read_b64_tr_b16 v[72:73], v14 offset:0
  ds_read_b64_tr_b16 v[74:75], v14 offset:2560
  s_waitcnt lgkmcnt(7)
  ds_read_b128 v[24:27], v111 offset:12288
  ds_read_b128 v[28:31], v109 offset:12288
  ds_read_b64_tr_b16 v[76:77], v112 offset:10240
  ds_read_b64_tr_b16 v[78:79], v112 offset:12800
  ds_read_b64_tr_b16 v[80:81], v15 offset:10240
  ds_read_b64_tr_b16 v[82:83], v15 offset:12800
  ds_read_b64_tr_b16 v[84:85], v14 offset:10240
  ds_read_b64_tr_b16 v[86:87], v14 offset:12800
  s_mul_i32 s29, s26, 73728
  s_add_u32 m0, s24, 40960
  s_nop 0
  buffer_load_dwordx4 v4, s[60:63], s29 offen lds
  s_add_u32 m0, s24, 46080
  s_nop 0
  buffer_load_dwordx4 v5, s[60:63], s29 offen lds
  s_add_u32 s29, s29, 36864
  s_add_u32 s26, s26, 1
  s_cmp_eq_u32 s26, 9
  s_cselect_b32 s26, 0, s26
  s_add_u32 m0, s24, 51200
  s_nop 0
  buffer_load_dwordx4 v4, s[60:63], s29 offen lds
  s_add_u32 m0, s24, 56320
  s_nop 0
  buffer_load_dwordx4 v5, s[60:63], s29 offen lds
  s_lshl_b32 s25, s27, 7
  s_add_u32 m0, s24, 72704
  s_add_u32 s27, s27, 1
  s_cmp_eq_u32 s27, 9
  s_cselect_b32 s27, 0, s27
  buffer_load_dwordx4 v6, s[56:59], s25 offen lds
  s_waitcnt lgkmcnt(8)
  v_mfma_f32_16x16x32_bf16 v[88:91], v[64:67], v[16:19], v[88:91]
  v_mfma_f32_16x16x32_bf16 v[92:95], v[64:67], v[20:23], v[92:95]
  v_mfma_f32_16x16x32_bf16 v[96:99], v[68:71], v[16:19], v[96:99]
  v_mfma_f32_16x16x32_bf16 v[100:103], v[68:71], v[20:23], v[100:103]
  v_mfma_f32_16x16x32_bf16 v[104:107], v[72:75], v[16:19], v[104:107]
  s_waitcnt lgkmcnt(0)
  v_mfma_f32_16x16x32_bf16 v[88:91], v[76:79], v[24:27], v[88:91]
  v_mfma_f32_16x16x32_bf16 v[92:95], v[76:79], v[28:31], v[92:95]
  v_mfma_f32_16x16x32_bf16 v[96:99], v[80:83], v[24:27], v[96:99]
  v_mfma_f32_16x16x32_bf16 v[100:103], v[80:83], v[28:31], v[100:103]
  v_mfma_f32_16x16x32_bf16 v[104:107], v[84:87], v[24:27], v[104:107]
  s_waitcnt vmcnt(6)
  s_barrier
  ds_read_b128 v[16:19], v110 offset:0
  ds_read_b128 v[20:23], v108 offset:0
  ds_read_b64_tr_b16 v[64:65], v112 offset:20480
  ds_read_b64_tr_b16 v[66:67], v112 offset:23040
  ds_read_b64_tr_b16 v[68:69], v15 offset:20480
  ds_read_b64_tr_b16 v[70:71], v15 offset:23040
  ds_read_b64_tr_b16 v[72:73], v14 offset:20480
  ds_read_b64_tr_b16 v[74:75], v14 offset:23040
  s_waitcnt lgkmcnt(7)
  ds_read_b128 v[24:27], v111 offset:0
  ds_read_b128 v[28:31], v109 offset:0
  ds_read_b64_tr_b16 v[76:77], v112 offset:30720
  ds_read_b64_tr_b16 v[78:79], v112 offset:33280
  ds_read_b64_tr_b16 v[80:81], v15 offset:30720
  ds_read_b64_tr_b16 v[82:83], v15 offset:33280
  ds_read_b64_tr_b16 v[84:85], v14 offset:30720
  ds_read_b64_tr_b16 v[86:87], v14 offset:33280
  s_mul_i32 s29, s26, 73728
  s_add_u32 m0, s24, 0
  s_nop 0
  buffer_load_dwordx4 v4, s[60:63], s29 offen lds
  s_add_u32 m0, s24, 5120
  s_nop 0
  buffer_load_dwordx4 v5, s[60:63], s29 offen lds
  s_add_u32 s29, s29, 36864
  s_add_u32 s26, s26, 1
  s_cmp_eq_u32 s26, 9
  s_cselect_b32 s26, 0, s26
  s_add_u32 m0, s24, 10240
  s_nop 0
  buffer_load_dwordx4 v4, s[60:63], s29 offen lds
  s_add_u32 m0, s24, 15360
  s_nop 0
  buffer_load_dwordx4 v5, s[60:63], s29 offen lds
  s_lshl_b32 s25, s27, 7
  s_add_u32 m0, s24, 76800
  s_add_u32 s27, s27, 1
  s_cmp_eq_u32 s27, 9
  s_cselect_b32 s27, 0, s27
  buffer_load_dwordx4 v6, s[56:59], s25 offen lds
  s_waitcnt lgkmcnt(8)
  v_mfma_f32_16x16x32_bf16 v[88:91], v[64:67], v[16:19], v[88:91]
  v_mfma_f32_16x16x32_bf16 v[92:95], v[64:67], v[20:23], v[92:95]
  v_mfma_f32_16x16x32_bf16 v[96:99], v[68:71], v[16:19], v[96:99]
  v_mfma_f32_16x16x32_bf16 v[100:103], v[68:71], v[20:23], v[100:103]
  v_mfma_f32_16x16x32_bf16 v[104:107], v[72:75], v[16:19], v[104:107]
  s_waitcnt lgkmcnt(0)
  v_mfma_f32_16x16x32_bf16 v[88:91], v[76:79], v[24:27], v[88:91]
  v_mfma_f32_16x16x32_bf16 v[92:95], v[76:79], v[28:31], v[92:95]
  v_mfma_f32_16x16x32_bf16 v[96:99], v[80:83], v[24:27], v[96:99]
  v_mfma_f32_16x16x32_bf16 v[100:103], v[80:83], v[28:31], v[100:103]
  v_mfma_f32_16x16x32_bf16 v[104:107], v[84:87], v[24:27], v[104:107]
  s_waitcnt vmcnt(6)
  s_barrier
  ds_read_b128 v[16:19], v110 offset:4096
  ds_read_b128 v[20:23], v108 offset:4096
  ds_read_b64_tr_b16 v[64:65], v112 offset:40960
  ds_read_b64_tr_b16 v[66:67], v112 offset:43520
  ds_read_b64_tr_b16 v[68:69], v15 offset:40960
  ds_read_b64_tr_b16 v[70:71], v15 offset:43520
  ds_read_b64_tr_b16 v[72:73], v14 offset:40960
  ds_read_b64_tr_b16 v[74:75], v14 offset:43520
  s_waitcnt lgkmcnt(7)
  ds_read_b128 v[24:27], v111 offset:4096
  ds_read_b128 v[28:31], v109 offset:4096
  ds_read_b64_tr_b16 v[76:77], v112 offset:51200
  ds_read_b64_tr_b16 v[78:79], v112 offset:53760
  ds_read_b64_tr_b16 v[80:81], v15 offset:51200
  ds_read_b64_tr_b16 v[82:83], v15 offset:53760
  ds_read_b64_tr_b16 v[84:85], v14 offset:51200
  ds_read_b64_tr_b16 v[86:87], v14 offset:53760
  s_mul_i32 s29, s26, 73728
  s_add_u32 m0, s24, 20480
  s_nop 0
  buffer_load_dwordx4 v4, s[60:63], s29 offen lds
  s_add_u32 m0, s24, 25600
  s_nop 0
  buffer_load_dwordx4 v5, s[60:63], s29 offen lds
  s_add_u32 s29, s29, 36864
  s_add_u32 s26, s26, 1
  s_cmp_eq_u32 s26, 9
  s_cselect_b32 s26, 0, s26
  s_add_u32 m0, s24, 30720
  s_nop 0
  buffer_load_dwordx4 v4, s[60:63], s29 offen lds
  s_add_u32 m0, s24, 35840
  s_nop 0
  buffer_load_dwordx4 v5, s[60:63], s29 offen lds
  s_lshl_b32 s25, s27, 7
  s_add_u32 m0, s24, 64512
  s_add_u32 s27, s27, 1
  s_cmp_eq_u32 s27, 9
  s_cselect_b32 s27, 0, s27
  buffer_load_dwordx4 v6, s[56:59], s25 offen lds
  s_waitcnt lgkmcnt(8)
  v_mfma_f32_16x16x32_bf16 v[88:91], v[64:67], v[16:19], v[88:91]
  v_mfma_f32_16x16x32_bf16 v[92:95], v[64:67], v[20:23], v[92:95]
  v_mfma_f32_16x16x32_bf16 v[96:99], v[68:71], v[16:19], v[96:99]
  v_mfma_f32_16x16x32_bf16 v[100:103], v[68:71], v[20:23], v[100:103]
  v_mfma_f32_16x16x32_bf16 v[104:107], v[72:75], v[16:19], v[104:107]
  s_waitcnt lgkmcnt(0)
  v_mfma_f32_16x16x32_bf16 v[88:91], v[76:79], v[24:27], v[88:91]
  v_mfma_f32_16x16x32_bf16 v[92:95], v[76:79], v[28:31], v[92:95]
  v_mfma_f32_16x16x32_bf16 v[96:99], v[80:83], v[24:27], v[96:99]
  v_mfma_f32_16x16x32_bf16 v[100:103], v[80:83], v[28:31], v[100:103]
  v_mfma_f32_16x16x32_bf16 v[104:107], v[84:87], v[24:27], v[104:107]
  s_waitcnt vmcnt(6)
  s_barrier
  ds_read_b128 v[16:19], v110 offset:8192
  ds_read_b128 v[20:23], v108 offset:8192
  ds_read_b64_tr_b16 v[64:65], v112 offset:0
  ds_read_b64_tr_b16 v[66:67], v112 offset:2560
  ds_read_b64_tr_b16 v[68:69], v15 offset:0
  ds_read_b64_tr_b16 v[70:71], v15 offset:2560
  ds_read_b64_tr_b16 v[72:73], v14 offset:0
  ds_read_b64_tr_b16 v[74:75], v14 offset:2560
  s_waitcnt lgkmcnt(7)
  ds_read_b128 v[24:27], v111 offset:8192
  ds_read_b128 v[28:31], v109 offset:8192
  ds_read_b64_tr_b16 v[76:77], v112 offset:10240
  ds_read_b64_tr_b16 v[78:79], v112 offset:12800
  ds_read_b64_tr_b16 v[80:81], v15 offset:10240
  ds_read_b64_tr_b16 v[82:83], v15 offset:12800
  ds_read_b64_tr_b16 v[84:85], v14 offset:10240
  ds_read_b64_tr_b16 v[86:87], v14 offset:12800
  s_mul_i32 s29, s26, 73728
  s_add_u32 m0, s24, 40960
  s_nop 0
  buffer_load_dwordx4 v4, s[60:63], s29 offen lds
  s_add_u32 m0, s24, 46080
  s_nop 0
  buffer_load_dwordx4 v5, s[60:63], s29 offen lds
  s_add_u32 s29, s29, 36864
  s_add_u32 s26, s26, 1
  s_cmp_eq_u32 s26, 9
  s_cselect_b32 s26, 0, s26
  s_add_u32 m0, s24, 51200
  s_nop 0
  buffer_load_dwordx4 v4, s[60:63], s29 offen lds
  s_add_u32 m0, s24, 56320
  s_nop 0
  buffer_load_dwordx4 v5, s[60:63], s29 offen lds
  s_waitcnt lgkmcnt(8)
  v_mfma_f32_16x16x32_bf16 v[88:91], v[64:67], v[16:19], v[88:91]
  v_mfma_f32_16x16x32_bf16 v[92:95], v[64:67], v[20:23], v[92:95]
  v_mfma_f32_16x16x32_bf16 v[96:99], v[68:71], v[16:19], v[96:99]
  v_mfma_f32_16x16x32_bf16 v[100:103], v[68:71], v[20:23], v[100:103]
  v_mfma_f32_16x16x32_bf16 v[104:107], v[72:75], v[16:19], v[104:107]
  s_waitcnt lgkmcnt(0)
  v_mfma_f32_16x16x32_bf16 v[88:91], v[76:79], v[24:27], v[88:91]
  v_mfma_f32_16x16x32_bf16 v[92:95], v[76:79], v[28:31], v[92:95]
  v_mfma_f32_16x16x32_bf16 v[96:99], v[80:83], v[24:27], v[96:99]
  v_mfma_f32_16x16x32_bf16 v[100:103], v[80:83], v[28:31], v[100:103]
  v_mfma_f32_16x16x32_bf16 v[104:107], v[84:87], v[24:27], v[104:107]
  s_waitcnt vmcnt(5)
  s_barrier
  ds_read_b128 v[16:19], v110 offset:12288
  ds_read_b128 v[20:23], v108 offset:12288
  ds_read_b64_tr_b16 v[64:65], v112 offset:20480
  ds_read_b64_tr_b16 v[66:67], v112 offset:23040
  ds_read_b64_tr_b16 v[68:69], v15 offset:20480
  ds_read_b64_tr_b16 v[70:71], v15 offset:23040
  ds_read_b64_tr_b16 v[72:73], v14 offset:20480
  ds_read_b64_tr_b16 v[74:75], v14 offset:23040
  s_waitcnt lgkmcnt(7)
  ds_read_b128 v[24:27], v111 offset:12288
  ds_read_b128 v[28:31], v109 offset:12288
  ds_read_b64_tr_b16 v[76:77], v112 offset:30720
  ds_read_b64_tr_b16 v[78:79], v112 offset:33280
  ds_read_b64_tr_b16 v[80:81], v15 offset:30720
  ds_read_b64_tr_b16 v[82:83], v15 offset:33280
  ds_read_b64_tr_b16 v[84:85], v14 offset:30720
  ds_read_b64_tr_b16 v[86:87], v14 offset:33280
  s_waitcnt lgkmcnt(8)
  v_mfma_f32_16x16x32_bf16 v[88:91], v[64:67], v[16:19], v[88:91]
  v_mfma_f32_16x16x32_bf16 v[92:95], v[64:67], v[20:23], v[92:95]
  v_mfma_f32_16x16x32_bf16 v[96:99], v[68:71], v[16:19], v[96:99]
  v_mfma_f32_16x16x32_bf16 v[100:103], v[68:71], v[20:23], v[100:103]
  v_mfma_f32_16x16x32_bf16 v[104:107], v[72:75], v[16:19], v[104:107]
  s_waitcnt lgkmcnt(0)
  v_mfma_f32_16x16x32_bf16 v[88:91], v[76:79], v[24:27], v[88:91]
  v_mfma_f32_16x16x32_bf16 v[92:95], v[76:79], v[28:31], v[92:95]
  v_mfma_f32_16x16x32_bf16 v[96:99], v[80:83], v[24:27], v[96:99]
  v_mfma_f32_16x16x32_bf16 v[100:103], v[80:83], v[28:31], v[100:103]
  v_mfma_f32_16x16x32_bf16 v[104:107], v[84:87], v[24:27], v[104:107]
  s_waitcnt vmcnt(0)
  s_barrier
  ds_read_b128 v[16:19], v110 offset:0
  ds_read_b128 v[20:23], v108 offset:0
  ds_read_b64_tr_b16 v[64:65], v112 offset:40960
  ds_read_b64_tr_b16 v[66:67], v112 offset:43520
  ds_read_b64_tr_b16 v[68:69], v15 offset:40960
  ds_read_b64_tr_b16 v[70:71], v15 offset:43520
  ds_read_b64_tr_b16 v[72:73], v14 offset:40960
  ds_read_b64_tr_b16 v[74:75], v14 offset:43520
  s_waitcnt lgkmcnt(7)
  ds_read_b128 v[24:27], v111 offset:0
  ds_read_b128 v[28:31], v109 offset:0
  ds_read_b64_tr_b16 v[76:77], v112 offset:51200
  ds_read_b64_tr_b16 v[78:79], v112 offset:53760
  ds_read_b64_tr_b16 v[80:81], v15 offset:51200
  ds_read_b64_tr_b16 v[82:83], v15 offset:53760
  ds_read_b64_tr_b16 v[84:85], v14 offset:51200
  ds_read_b64_tr_b16 v[86:87], v14 offset:53760
  s_waitcnt lgkmcnt(8)
  v_mfma_f32_16x16x32_bf16 v[88:91], v[64:67], v[16:19], v[88:91]
  v_mfma_f32_16x16x32_bf16 v[92:95], v[64:67], v[20:23], v[92:95]
  v_mfma_f32_16x16x32_bf16 v[96:99], v[68:71], v[16:19], v[96:99]
  v_mfma_f32_16x16x32_bf16 v[100:103], v[68:71], v[20:23], v[100:103]
  v_mfma_f32_16x16x32_bf16 v[104:107], v[72:75], v[16:19], v[104:107]
  s_waitcnt lgkmcnt(0)
  v_mfma_f32_16x16x32_bf16 v[88:91], v[76:79], v[24:27], v[88:91]
  v_mfma_f32_16x16x32_bf16 v[92:95], v[76:79], v[28:31], v[92:95]
  v_mfma_f32_16x16x32_bf16 v[96:99], v[80:83], v[24:27], v[96:99]
  v_mfma_f32_16x16x32_bf16 v[100:103], v[80:83], v[28:31], v[100:103]
  v_mfma_f32_16x16x32_bf16 v[104:107], v[84:87], v[24:27], v[104:107]
  s_barrier
  s_mov_b32 s30, 0x3eae1a93
  v_mul_u32_u24 v8, 304, v113
  v_lshl_add_u32 v8, v114, 3, v8
  v_add_u32 v8, 58368, v8
  s_mul_i32 s3, s23, 4864
  v_add_u32 v9, s3, v8
  s_xor_b32 s25, s23, 1
  s_mul_i32 s25, s25, 4864
  s_lshl_b32 s3, s20, 6
  s_add_u32 s25, s25, s3
  v_add_u32 v10, s25, v8
  v_add_u32 v8, s3, v9
  v_mul_f32 v88, s30, v88
  v_mul_f32 v89, s30, v89
  v_mul_f32 v90, s30, v90
  v_mul_f32 v91, s30, v91
  v_cvt_pk_bf16_f32 v32, v88, v89
  v_cvt_pk_bf16_f32 v33, v90, v91
  ds_write_b64 v8, v[32:33] offset:0
  v_mul_f32 v92, s30, v92
  v_mul_f32 v93, s30, v93
  v_mul_f32 v94, s30, v94
  v_mul_f32 v95, s30, v95
  v_cvt_pk_bf16_f32 v34, v92, v93
  v_cvt_pk_bf16_f32 v35, v94, v95
  ds_write_b64 v10, v[34:35] offset:0
  v_mul_f32 v96, s30, v96
  v_mul_f32 v97, s30, v97
  v_mul_f32 v98, s30, v98
  v_mul_f32 v99, s30, v99
  v_cvt_pk_bf16_f32 v36, v96, v97
  v_cvt_pk_bf16_f32 v37, v98, v99
  ds_write_b64 v8, v[36:37] offset:32
  v_mul_f32 v100, s30, v100
  v_mul_f32 v101, s30, v101
  v_mul_f32 v102, s30, v102
  v_mul_f32 v103, s30, v103
  v_cvt_pk_bf16_f32 v38, v100, v101
  v_cvt_pk_bf16_f32 v39, v102, v103
  ds_write_b64 v10, v[38:39] offset:32
  v_mul_f32 v104, s30, v104
  v_mul_f32 v105, s30, v105
  v_mul_f32 v106, s30, v106
  v_mul_f32 v107, s30, v107
  v_cvt_pk_bf16_f32 v40, v104, v105
  v_cvt_pk_bf16_f32 v41, v106, v107
  ds_write_b64 v9, v[40:41] offset:256
  s_waitcnt lgkmcnt(0)
  s_barrier
  s_setprio 1
  s_and_b32 s21, s2, 7
  s_lshl_b32 s21, s21, 3
  s_lshr_b32 s3, s2, 5
  s_add_u32 s21, s21, s3
  s_bfe_u32 s22, s2, 0x20003
  s_lshl_b32 s22, s22, 2
  s_add_u32 s22, s22, s20
  s_mul_i32 s23, s20, 4864
  v_and_b32 v84, 31, v2
  v_lshrrev_b32 v93, 5, v2
  s_lshl_b32 s3, s21, 5
  v_add_u32 v84, s3, v84
  v_mul_u32_u24 v92, 1152, v84
  s_mul_i32 s3, s22, 72
  v_add_u32 v92, s3, v92
  v_lshl_add_u32 v85, v93, 4, v92
  v_lshlrev_b32 v3, 4, v2
  v_lshlrev_b32 v86, 3, v2
  v_add_u32 v86, 2514944, v86
  s_waitcnt lgkmcnt(0)
  s_mov_b32 s16, s12
  s_and_b32 s17, s13, 0xffff
  s_mov_b32 s18, 16777216
  s_mov_b32 s19, 0x00020000
  v_and_b32 v87, 31, v2
  v_mul_u32_u24 v87, 304, v87
  s_mul_i32 s3, s20, 72
  s_add_u32 s3, s3, 58368
  v_add_u32 v87, s3, v87
  v_lshl_add_u32 v88, v93, 4, v87
  ds_read2_b32 v[4:5], v88 offset0:0 offset1:1
  ds_read2_b32 v[6:7], v88 offset0:2 offset1:3
  ds_read_b32 v12, v87 offset:32
  ds_read2_b32 v[8:9], v88 offset0:9 offset1:10
  ds_read2_b32 v[10:11], v88 offset0:11 offset1:12
  ds_read_b32 v14, v87 offset:68
  v_and_b32 v84, 31, v2
  v_min_u32 v84, 19, v84
  v_mul_u32_u24 v85, 20, v93
  v_add_u32 v84, v84, v85
  v_lshlrev_b32 v126, 4, v84
  v_add_u32 v126, 8192, v126
  v_mov_b32 v1, v126
  v_mov_b32 v0, 0xdddd
  v_mov_b32 v125, 0x3f803f80
  s_mov_b32 s36, 304
  s_mov_b32 s38, 0xffff1c00
  s_mov_b32 s39, 19456
  s_mov_b32 s37, 1152
  v_mov_b32 v68, 0
  v_mov_b32 v69, 0
  v_mov_b32 v70, 0
  v_mov_b32 v71, 0
  v_mov_b32 v72, 0
  v_mov_b32 v73, 0
  v_mov_b32 v74, 0
  v_mov_b32 v75, 0
  v_mov_b32 v76, 0
  v_mov_b32 v77, 0
  v_mov_b32 v78, 0
  v_mov_b32 v79, 0
  v_mov_b32 v80, 0
  v_mov_b32 v81, 0
  v_mov_b32 v82, 0
  v_mov_b32 v83, 0
  v_mov_b32 v120, 0
  v_mov_b32 v121, 0
  v_mov_b32 v122, 0
  v_mov_b32 v123, 0
  v_mov_b32 v60, 0
  v_mov_b32 v61, 0
  v_mov_b32 v62, 0
  v_mov_b32 v63, 0
  v_mov_b32 v64, 0
  v_mov_b32 v65, 0
  v_mov_b32 v66, 0
  v_mov_b32 v67, 0
  s_waitcnt vmcnt(0) lgkmcnt(0)
  v_cmp_eq_u32 vcc, 0, v93
  v_mov_b32 v96, 0
  v_mov_b32 v97, 0
  v_cndmask_b32 v84, 0, v12, vcc
  v_cndmask_b32 v85, 0, v14, vcc
  v_dot2c_f32_bf16 v96, v4, v4
  v_dot2c_f32_bf16 v97, v8, v8
  v_dot2c_f32_bf16 v96, v5, v5
  v_dot2c_f32_bf16 v97, v9, v9
  v_dot2c_f32_bf16 v96, v6, v6
  v_dot2c_f32_bf16 v97, v10, v10
  v_dot2c_f32_bf16 v96, v7, v7
  v_dot2c_f32_bf16 v97, v11, v11
  v_dot2c_f32_bf16 v96, v84, v84
  v_dot2c_f32_bf16 v97, v85, v85
  s_nop 3
  v_mov_b32 v86, v96
  v_mov_b32 v87, v97
  s_nop 1
  v_permlane32_swap_b32 v96, v86
  v_permlane32_swap_b32 v97, v87
  s_nop 1
  v_add_f32 v96, v96, v86
  v_add_f32 v97, v97, v87
  v_lshlrev_b32 v91, 2, v2
  v_add_u32 v91, 77824, v91
  s_barrier
  ds_read_b32 v94, v91
  s_waitcnt lgkmcnt(0)
  s_nop 1
  v_max_f32_dpp v94, v94, v94 row_ror:8 row_mask:0xf bank_mask:0xf
  s_nop 1
  v_max_f32_dpp v94, v94, v94 row_ror:4 row_mask:0xf bank_mask:0xf
  s_nop 1
  v_max_f32_dpp v94, v94, v94 row_ror:2 row_mask:0xf bank_mask:0xf
  s_nop 1
  v_max_f32_dpp v94, v94, v94 row_ror:1 row_mask:0xf bank_mask:0xf
  v_mov_b32 v89, v94
  s_nop 1
  v_permlane16_swap_b32 v94, v89
  s_nop 1
  v_max_f32 v94, v94, v89
  v_mov_b32 v89, v94
  s_nop 1
  v_permlane32_swap_b32 v94, v89
  s_nop 1
  v_max_f32 v94, v94, v89
  v_mul_f32 v96, v96, v94
  v_mul_f32 v97, v97, v94
  v_sqrt_f32 v96, v96
  v_sqrt_f32 v97, v97
  s_nop 0
  v_mul_f32 v96, 0x3f810000, v96
  v_mul_f32 v97, 0x3f810000, v97
  v_mov_b32 v87, 0x42000000
  v_cmp_le_f32 vcc, v96, v87
  v_cmp_le_f32 s[26:27], v97, v87
  s_nop 3
  s_and_b64 s[26:27], s[26:27], vcc
  s_cmp_eq_u64 s[26:27], -1
  s_cbranch_scc1 L_fast_1
  v_cmp_eq_u32 vcc, 0, v93
  v_mov_b32 v17, 0
  v_mov_b32 v19, 0
  v_cndmask_b32 v16, 0, v12, vcc
  v_cndmask_b32 v18, 0, v14, vcc
  v_add_u32 v85, 2359296, v3
  v_and_b32 v86, 31, v2
  v_lshlrev_b32 v86, 2, v86
  v_add_u32 v86, 2377728, v86
  v_mov_b32 v96, 0xff800000
  v_mov_b32 v97, 0xff800000
  s_mov_b32 s25, 0
L_slow_2:
  s_lshr_b32 s3, s25, 3
  s_mul_i32 s3, s3, 19456
  s_and_b32 s24, s25, 7
  s_lshl_b32 s28, s24, 10
  s_add_u32 s28, s28, s3
  s_lshl_b32 s29, s24, 7
  s_add_u32 s29, s29, s3
  buffer_load_dwordx4 v[100:103], v85, s[16:19], s28 offen sc1
  buffer_load_dword v124, v86, s[16:19], s29 offen sc1
  s_waitcnt vmcnt(0)
  v_mfma_f32_32x32x16_bf16 v[20:35], v[100:103], v[4:7], 0
  v_mfma_f32_32x32x8_bf16 v[20:35], v[124:125], v[16:17], v[20:35]
  v_mfma_f32_32x32x16_bf16 v[36:51], v[100:103], v[8:11], 0
  v_mfma_f32_32x32x8_bf16 v[36:51], v[124:125], v[18:19], v[36:51]
  s_nop 15
  v_max3_f32 v96, v20, v21, v96
  v_max3_f32 v96, v22, v23, v96
  v_max3_f32 v96, v24, v25, v96
  v_max3_f32 v96, v26, v27, v96
  v_max3_f32 v96, v28, v29, v96
  v_max3_f32 v96, v30, v31, v96
  v_max3_f32 v96, v32, v33, v96
  v_max3_f32 v96, v34, v35, v96
  v_max3_f32 v97, v36, v37, v97
  v_max3_f32 v97, v38, v39, v97
  v_max3_f32 v97, v40, v41, v97
  v_max3_f32 v97, v42, v43, v97
  v_max3_f32 v97, v44, v45, v97
  v_max3_f32 v97, v46, v47, v97
  v_max3_f32 v97, v48, v49, v97
  v_max3_f32 v97, v50, v51, v97
  s_add_u32 s25, s25, 1
  s_cmp_lt_u32 s25, 64
  s_cbranch_scc1 L_slow_2
  v_mov_b32 v86, v96
  v_mov_b32 v87, v97
  s_nop 1
  v_permlane32_swap_b32 v96, v86
  v_permlane32_swap_b32 v97, v87
  s_nop 1
  v_max_f32 v96, v96, v86
  v_max_f32 v97, v97, v87
L_fast_1:
  v_cmp_eq_u32 vcc, 0, v93
  v_and_b32 v85, 0xffff0000, v96
  v_sub_f32 v86, v96, v85
  v_cvt_pk_bf16_f32 v85, -v85, -v86
  v_cndmask_b32 v16, v12, 0, vcc
  v_cndmask_b32 v17, v85, 0, vcc
  v_cndmask_b32 v13, 0, v85, vcc
  v_cndmask_b32 v12, 0, v12, vcc
  v_and_b32 v85, 0xffff0000, v97
  v_sub_f32 v86, v97, v85
  v_cvt_pk_bf16_f32 v85, -v85, -v86
  v_cndmask_b32 v18, v14, 0, vcc
  v_cndmask_b32 v19, v85, 0, vcc
  v_cndmask_b32 v15, 0, v85, vcc
  v_cndmask_b32 v14, 0, v14, vcc
  v_lshlrev_b32 v2, 2, v2
  v_add_u32 v2, 18432, v2
  v_mov_b32 v84, 0
  v_mov_b32 v85, 0
  v_mov_b32 v86, 0
  v_mov_b32 v87, 0
  v_mov_b32 v88, 0
  v_mov_b32 v89, 0
  v_mov_b32 v90, 0
  v_mov_b32 v91, 0
  v_mov_b32 v92, 0
  v_mov_b32 v93, 0
  v_mov_b32 v94, 0
  v_mov_b32 v95, 0
  v_mov_b32 v96, 0
  v_mov_b32 v97, 0
  v_mov_b32 v98, 0
  v_mov_b32 v99, 0
  s_barrier
  ds_read_b128 v[100:103], v3 offset:0
  ds_read_b32 v124, v2 offset:0
  ds_read_b128 v[104:107], v3 offset:1024
  ds_read_b128 v[108:111], v126 offset:0
  ds_read_b128 v[116:119], v1 offset:640
  ds_read_b128 v[112:115], v126 offset:1280
  s_waitcnt lgkmcnt(4)
  v_mfma_f32_32x32x16_bf16 v[20:35], v[100:103], v[4:7], 0
  v_mfma_f32_32x32x8_bf16 v[20:35], v[124:125], v[12:13], v[20:35]
  s_mov_b32 s24, 0
  s_waitcnt lgkmcnt(0)
  s_nop 7
  s_nop 3
  .p2align 6
L_chunk_3:
  s_and_b32 s32, s24, 3
  s_cmp_eq_u32 s32, 3
  s_cselect_b32 s32, s38, s39
  v_mfma_f32_32x32x16_bf16 v[36:51], v[100:103], v[8:11], 0
  ds_read_b128 v[100:103], v3 offset:2048
  v_exp_f32 v52, v20
  v_exp_f32 v53, v21
  v_exp_f32 v54, v22
  v_exp_f32 v55, v23
  v_smfmac_f32_32x32x32_bf16 v[84:99], v[120:123], v[60:67], v0
  ds_read_b128 v[120:123], v1 offset:1920
  v_exp_f32 v56, v24
  v_exp_f32 v57, v25
  v_exp_f32 v58, v26
  v_exp_f32 v59, v27
  v_mfma_f32_32x32x8_bf16 v[36:51], v[124:125], v[14:15], v[36:51]
  v_exp_f32 v60, v28
  v_exp_f32 v61, v29
  v_exp_f32 v62, v30
  v_exp_f32 v63, v31
  v_smfmac_f32_32x32x32_bf16 v[68:83], v[108:111], v[52:59], v0
  s_waitcnt lgkmcnt(2)
  v_exp_f32 v64, v32
  v_exp_f32 v65, v33
  v_exp_f32 v66, v34
  v_exp_f32 v67, v35
  v_mfma_f32_32x32x16_bf16 v[20:35], v[104:107], v[4:7], 0
  v_exp_f32 v52, v36
  v_exp_f32 v53, v37
  v_exp_f32 v54, v38
  v_exp_f32 v55, v39
  v_smfmac_f32_32x32x32_bf16 v[68:83], v[116:119], v[60:67], v0
  v_exp_f32 v56, v40
  v_exp_f32 v57, v41
  v_exp_f32 v58, v42
  v_exp_f32 v59, v43
  v_mfma_f32_32x32x8_bf16 v[20:35], v[124:125], v[16:17], v[20:35]
  v_exp_f32 v60, v44
  v_exp_f32 v61, v45
  v_exp_f32 v62, v46
  v_exp_f32 v63, v47
  v_smfmac_f32_32x32x32_bf16 v[84:99], v[108:111], v[52:59], v0
  ds_read_b128 v[108:111], v126 offset:2560
  v_exp_f32 v64, v48
  v_exp_f32 v65, v49
  v_exp_f32 v66, v50
  v_exp_f32 v67, v51
  v_mfma_f32_32x32x16_bf16 v[36:51], v[104:107], v[8:11], 0
  ds_read_b128 v[104:107], v3 offset:3072
  v_exp_f32 v52, v20
  v_exp_f32 v53, v21
  v_exp_f32 v54, v22
  v_exp_f32 v55, v23
  v_smfmac_f32_32x32x32_bf16 v[84:99], v[116:119], v[60:67], v0
  ds_read_b128 v[116:119], v1 offset:3200
  v_exp_f32 v56, v24
  v_exp_f32 v57, v25
  v_exp_f32 v58, v26
  v_exp_f32 v59, v27
  v_mfma_f32_32x32x8_bf16 v[36:51], v[124:125], v[18:19], v[36:51]
  ds_read_b32 v124, v2 offset:256
  v_exp_f32 v60, v28
  v_exp_f32 v61, v29
  v_exp_f32 v62, v30
  v_exp_f32 v63, v31
  v_smfmac_f32_32x32x32_bf16 v[68:83], v[112:115], v[52:59], v0
  s_waitcnt lgkmcnt(3)
  v_exp_f32 v64, v32
  v_exp_f32 v65, v33
  v_exp_f32 v66, v34
  v_exp_f32 v67, v35
  v_mfma_f32_32x32x16_bf16 v[20:35], v[100:103], v[4:7], 0
  v_exp_f32 v52, v36
  v_exp_f32 v53, v37
  v_exp_f32 v54, v38
  v_exp_f32 v55, v39
  v_smfmac_f32_32x32x32_bf16 v[68:83], v[120:123], v[60:67], v0
  s_waitcnt lgkmcnt(0)
  v_exp_f32 v56, v40
  v_exp_f32 v57, v41
  v_exp_f32 v58, v42
  v_exp_f32 v59, v43
  v_mfma_f32_32x32x8_bf16 v[20:35], v[124:125], v[12:13], v[20:35]
  v_exp_f32 v60, v44
  v_exp_f32 v61, v45
  v_exp_f32 v62, v46
  v_exp_f32 v63, v47
  v_smfmac_f32_32x32x32_bf16 v[84:99], v[112:115], v[52:59], v0
  ds_read_b128 v[112:115], v126 offset:3840
  v_exp_f32 v64, v48
  v_exp_f32 v65, v49
  v_exp_f32 v66, v50
  v_exp_f32 v67, v51
  v_mfma_f32_32x32x16_bf16 v[36:51], v[100:103], v[8:11], 0
  ds_read_b128 v[100:103], v3 offset:4096
  v_exp_f32 v52, v20
  v_exp_f32 v53, v21
  v_exp_f32 v54, v22
  v_exp_f32 v55, v23
  v_smfmac_f32_32x32x32_bf16 v[84:99], v[120:123], v[60:67], v0
  ds_read_b128 v[120:123], v1 offset:4480
  v_exp_f32 v56, v24
  v_exp_f32 v57, v25
  v_exp_f32 v58, v26
  v_exp_f32 v59, v27
  v_mfma_f32_32x32x8_bf16 v[36:51], v[124:125], v[14:15], v[36:51]
  v_exp_f32 v60, v28
  v_exp_f32 v61, v29
  v_exp_f32 v62, v30
  v_exp_f32 v63, v31
  v_smfmac_f32_32x32x32_bf16 v[68:83], v[108:111], v[52:59], v0
  s_waitcnt lgkmcnt(2)
  v_exp_f32 v64, v32
  v_exp_f32 v65, v33
  v_exp_f32 v66, v34
  v_exp_f32 v67, v35
  v_mfma_f32_32x32x16_bf16 v[20:35], v[104:107], v[4:7], 0
  v_exp_f32 v52, v36
  v_exp_f32 v53, v37
  v_exp_f32 v54, v38
  v_exp_f32 v55, v39
  v_smfmac_f32_32x32x32_bf16 v[68:83], v[116:119], v[60:67], v0
  v_exp_f32 v56, v40
  v_exp_f32 v57, v41
  v_exp_f32 v58, v42
  v_exp_f32 v59, v43
  v_mfma_f32_32x32x8_bf16 v[20:35], v[124:125], v[16:17], v[20:35]
  v_exp_f32 v60, v44
  v_exp_f32 v61, v45
  v_exp_f32 v62, v46
  v_exp_f32 v63, v47
  v_smfmac_f32_32x32x32_bf16 v[84:99], v[108:111], v[52:59], v0
  ds_read_b128 v[108:111], v126 offset:5120
  v_exp_f32 v64, v48
  v_exp_f32 v65, v49
  v_exp_f32 v66, v50
  v_exp_f32 v67, v51
  v_mfma_f32_32x32x16_bf16 v[36:51], v[104:107], v[8:11], 0
  ds_read_b128 v[104:107], v3 offset:5120
  v_exp_f32 v52, v20
  v_exp_f32 v53, v21
  v_exp_f32 v54, v22
  v_exp_f32 v55, v23
  v_smfmac_f32_32x32x32_bf16 v[84:99], v[116:119], v[60:67], v0
  ds_read_b128 v[116:119], v1 offset:5760
  v_exp_f32 v56, v24
  v_exp_f32 v57, v25
  v_exp_f32 v58, v26
  v_exp_f32 v59, v27
  v_mfma_f32_32x32x8_bf16 v[36:51], v[124:125], v[18:19], v[36:51]
  ds_read_b32 v124, v2 offset:512
  v_exp_f32 v60, v28
  v_exp_f32 v61, v29
  v_exp_f32 v62, v30
  v_exp_f32 v63, v31
  v_smfmac_f32_32x32x32_bf16 v[68:83], v[112:115], v[52:59], v0
  s_waitcnt lgkmcnt(3)
  v_exp_f32 v64, v32
  v_exp_f32 v65, v33
  v_exp_f32 v66, v34
  v_exp_f32 v67, v35
  v_mfma_f32_32x32x16_bf16 v[20:35], v[100:103], v[4:7], 0
  v_exp_f32 v52, v36
  v_exp_f32 v53, v37
  v_exp_f32 v54, v38
  v_exp_f32 v55, v39
  v_smfmac_f32_32x32x32_bf16 v[68:83], v[120:123], v[60:67], v0
  s_waitcnt lgkmcnt(0)
  v_exp_f32 v56, v40
  v_exp_f32 v57, v41
  v_exp_f32 v58, v42
  v_exp_f32 v59, v43
  v_mfma_f32_32x32x8_bf16 v[20:35], v[124:125], v[12:13], v[20:35]
  v_exp_f32 v60, v44
  v_exp_f32 v61, v45
  v_exp_f32 v62, v46
  v_exp_f32 v63, v47
  v_smfmac_f32_32x32x32_bf16 v[84:99], v[112:115], v[52:59], v0
  ds_read_b128 v[112:115], v126 offset:6400
  v_exp_f32 v64, v48
  v_exp_f32 v65, v49
  v_exp_f32 v66, v50
  v_exp_f32 v67, v51
  v_mfma_f32_32x32x16_bf16 v[36:51], v[100:103], v[8:11], 0
  ds_read_b128 v[100:103], v3 offset:6144
  v_exp_f32 v52, v20
  v_exp_f32 v53, v21
  v_exp_f32 v54, v22
  v_exp_f32 v55, v23
  v_smfmac_f32_32x32x32_bf16 v[84:99], v[120:123], v[60:67], v0
  ds_read_b128 v[120:123], v1 offset:7040
  v_exp_f32 v56, v24
  v_exp_f32 v57, v25
  v_exp_f32 v58, v26
  v_exp_f32 v59, v27
  v_mfma_f32_32x32x8_bf16 v[36:51], v[124:125], v[14:15], v[36:51]
  v_exp_f32 v60, v28
  v_exp_f32 v61, v29
  v_exp_f32 v62, v30
  v_exp_f32 v63, v31
  v_smfmac_f32_32x32x32_bf16 v[68:83], v[108:111], v[52:59], v0
  s_waitcnt lgkmcnt(2)
  v_exp_f32 v64, v32
  v_exp_f32 v65, v33
  v_exp_f32 v66, v34
  v_exp_f32 v67, v35
  v_mfma_f32_32x32x16_bf16 v[20:35], v[104:107], v[4:7], 0
  v_exp_f32 v52, v36
  v_exp_f32 v53, v37
  v_exp_f32 v54, v38
  v_exp_f32 v55, v39
  v_smfmac_f32_32x32x32_bf16 v[68:83], v[116:119], v[60:67], v0
  v_exp_f32 v56, v40
  v_exp_f32 v57, v41
  v_exp_f32 v58, v42
  v_exp_f32 v59, v43
  v_mfma_f32_32x32x8_bf16 v[20:35], v[124:125], v[16:17], v[20:35]
  v_exp_f32 v60, v44
  v_exp_f32 v61, v45
  v_exp_f32 v62, v46
  v_exp_f32 v63, v47
  v_smfmac_f32_32x32x32_bf16 v[84:99], v[108:111], v[52:59], v0
  ds_read_b128 v[108:111], v126 offset:7680
  v_exp_f32 v64, v48
  v_exp_f32 v65, v49
  v_exp_f32 v66, v50
  v_exp_f32 v67, v51
  v_mfma_f32_32x32x16_bf16 v[36:51], v[104:107], v[8:11], 0
  ds_read_b128 v[104:107], v3 offset:7168
  v_exp_f32 v52, v20
  v_exp_f32 v53, v21
  v_exp_f32 v54, v22
  v_exp_f32 v55, v23
  v_smfmac_f32_32x32x32_bf16 v[84:99], v[116:119], v[60:67], v0
  ds_read_b128 v[116:119], v1 offset:8320
  v_exp_f32 v56, v24
  v_exp_f32 v57, v25
  v_exp_f32 v58, v26
  v_exp_f32 v59, v27
  v_mfma_f32_32x32x8_bf16 v[36:51], v[124:125], v[18:19], v[36:51]
  ds_read_b32 v124, v2 offset:768
  v_exp_f32 v60, v28
  v_exp_f32 v61, v29
  v_exp_f32 v62, v30
  v_exp_f32 v63, v31
  v_smfmac_f32_32x32x32_bf16 v[68:83], v[112:115], v[52:59], v0
  s_waitcnt lgkmcnt(3)
  v_exp_f32 v64, v32
  v_exp_f32 v65, v33
  v_exp_f32 v66, v34
  v_exp_f32 v67, v35
  v_mfma_f32_32x32x16_bf16 v[20:35], v[100:103], v[4:7], 0
  v_exp_f32 v52, v36
  v_exp_f32 v53, v37
  v_exp_f32 v54, v38
  v_exp_f32 v55, v39
  v_smfmac_f32_32x32x32_bf16 v[68:83], v[120:123], v[60:67], v0
  s_waitcnt lgkmcnt(0)
  v_exp_f32 v56, v40
  v_exp_f32 v57, v41
  v_exp_f32 v58, v42
  v_exp_f32 v59, v43
  v_mfma_f32_32x32x8_bf16 v[20:35], v[124:125], v[12:13], v[20:35]
  v_exp_f32 v60, v44
  v_exp_f32 v61, v45
  v_exp_f32 v62, v46
  v_exp_f32 v63, v47
  v_smfmac_f32_32x32x32_bf16 v[84:99], v[112:115], v[52:59], v0
  ds_read_b128 v[112:115], v126 offset:8960
  v_exp_f32 v64, v48
  v_exp_f32 v65, v49
  v_exp_f32 v66, v50
  v_exp_f32 v67, v51
  s_barrier
  v_add_u32 v3, s32, v3
  v_add_u32 v126, s32, v126
  v_mfma_f32_32x32x16_bf16 v[36:51], v[100:103], v[8:11], 0
  ds_read_b128 v[100:103], v3 offset:0
  v_exp_f32 v52, v20
  v_exp_f32 v53, v21
  v_exp_f32 v54, v22
  v_exp_f32 v55, v23
  v_smfmac_f32_32x32x32_bf16 v[84:99], v[120:123], v[60:67], v0
  ds_read_b128 v[120:123], v1 offset:9600
  v_exp_f32 v56, v24
  v_exp_f32 v57, v25
  v_exp_f32 v58, v26
  v_exp_f32 v59, v27
  v_mfma_f32_32x32x8_bf16 v[36:51], v[124:125], v[14:15], v[36:51]
  v_exp_f32 v60, v28
  v_exp_f32 v61, v29
  v_exp_f32 v62, v30
  v_exp_f32 v63, v31
  v_smfmac_f32_32x32x32_bf16 v[68:83], v[108:111], v[52:59], v0
  s_waitcnt lgkmcnt(2)
  v_exp_f32 v64, v32
  v_exp_f32 v65, v33
  v_exp_f32 v66, v34
  v_exp_f32 v67, v35
  v_mfma_f32_32x32x16_bf16 v[20:35], v[104:107], v[4:7], 0
  v_exp_f32 v52, v36
  v_exp_f32 v53, v37
  v_exp_f32 v54, v38
  v_exp_f32 v55, v39
  v_smfmac_f32_32x32x32_bf16 v[68:83], v[116:119], v[60:67], v0
  v_exp_f32 v56, v40
  v_exp_f32 v57, v41
  v_exp_f32 v58, v42
  v_exp_f32 v59, v43
  v_mfma_f32_32x32x8_bf16 v[20:35], v[124:125], v[16:17], v[20:35]
  v_exp_f32 v60, v44
  v_exp_f32 v61, v45
  v_exp_f32 v62, v46
  v_exp_f32 v63, v47
  v_smfmac_f32_32x32x32_bf16 v[84:99], v[108:111], v[52:59], v0
  ds_read_b128 v[108:111], v126 offset:0
  v_exp_f32 v64, v48
  v_exp_f32 v65, v49
  v_exp_f32 v66, v50
  v_exp_f32 v67, v51
  v_add_u32 v1, s32, v1
  v_add_u32 v2, s32, v2
  v_mfma_f32_32x32x16_bf16 v[36:51], v[104:107], v[8:11], 0
  ds_read_b128 v[104:107], v3 offset:1024
  v_exp_f32 v52, v20
  v_exp_f32 v53, v21
  v_exp_f32 v54, v22
  v_exp_f32 v55, v23
  v_smfmac_f32_32x32x32_bf16 v[84:99], v[116:119], v[60:67], v0
  ds_read_b128 v[116:119], v1 offset:640
  v_exp_f32 v56, v24
  v_exp_f32 v57, v25
  v_exp_f32 v58, v26
  v_exp_f32 v59, v27
  v_mfma_f32_32x32x8_bf16 v[36:51], v[124:125], v[18:19], v[36:51]
  ds_read_b32 v124, v2 offset:0
  v_exp_f32 v60, v28
  v_exp_f32 v61, v29
  v_exp_f32 v62, v30
  v_exp_f32 v63, v31
  v_smfmac_f32_32x32x32_bf16 v[68:83], v[112:115], v[52:59], v0
  s_waitcnt lgkmcnt(3)
  v_exp_f32 v64, v32
  v_exp_f32 v65, v33
  v_exp_f32 v66, v34
  v_exp_f32 v67, v35
  v_mfma_f32_32x32x16_bf16 v[20:35], v[100:103], v[4:7], 0
  v_exp_f32 v52, v36
  v_exp_f32 v53, v37
  v_exp_f32 v54, v38
  v_exp_f32 v55, v39
  v_smfmac_f32_32x32x32_bf16 v[68:83], v[120:123], v[60:67], v0
  s_waitcnt lgkmcnt(0)
  v_exp_f32 v56, v40
  v_exp_f32 v57, v41
  v_exp_f32 v58, v42
  v_exp_f32 v59, v43
  v_mfma_f32_32x32x8_bf16 v[20:35], v[124:125], v[12:13], v[20:35]
  v_exp_f32 v60, v44
  v_exp_f32 v61, v45
  v_exp_f32 v62, v46
  v_exp_f32 v63, v47
  v_smfmac_f32_32x32x32_bf16 v[84:99], v[112:115], v[52:59], v0
  ds_read_b128 v[112:115], v126 offset:1280
  v_exp_f32 v64, v48
  v_exp_f32 v65, v49
  v_exp_f32 v66, v50
  v_exp_f32 v67, v51
  s_add_u32 s24, s24, 1
  s_cmp_lt_u32 s24, 8
  s_cbranch_scc1 L_chunk_3
  s_waitcnt lgkmcnt(0)
  v_smfmac_f32_32x32x32_bf16 v[84:99], v[120:123], v[60:67], v0
  s_setprio 3
  v_mbcnt_lo_u32_b32 v2, -1, 0
  v_mbcnt_hi_u32_b32 v2, -1, v2
  s_lshl_b32 s3, s20, 6
  v_lshrrev_b32 v126, 5, v2
  v_add_u32 v3, s3, v2
  v_and_b32 v102, 31, v2
  v_mul_u32_u24 v102, 304, v102
  v_lshl_add_u32 v102, v126, 3, v102
  s_mul_i32 s3, s20, 72
  s_add_u32 s3, s3, 38912
  v_add_u32 v102, s3, v102
  v_mov_b32 v100, v78
  v_mov_b32 v101, v78
  s_nop 1
  v_permlane32_swap_b32 v100, v101
  s_nop 1
  v_rcp_f32 v100, v100
  s_nop 0
  v_mul_f32 v68, v68, v100
  v_mul_f32 v69, v69, v100
  v_mul_f32 v70, v70, v100
  v_mul_f32 v71, v71, v100
  v_mul_f32 v72, v72, v100
  v_mul_f32 v73, v73, v100
  v_mul_f32 v74, v74, v100
  v_mul_f32 v75, v75, v100
  v_mul_f32 v76, v76, v100
  v_mul_f32 v77, v77, v100
  v_cvt_pk_bf16_f32 v20, v68, v69
  v_cvt_pk_bf16_f32 v21, v70, v71
  v_cvt_pk_bf16_f32 v22, v72, v73
  v_cvt_pk_bf16_f32 v23, v74, v75
  v_cvt_pk_bf16_f32 v24, v76, v77
  ds_write2_b32 v102, v20, v21 offset0:0 offset1:1
  ds_write2_b32 v102, v22, v23 offset0:4 offset1:5
  s_mov_b64 exec, 0xffffffff
  ds_write_b32 v102, v24 offset:32
  s_mov_b64 exec, -1
  s_nop 3
  v_mov_b32 v100, v94
  v_mov_b32 v101, v94
  s_nop 1
  v_permlane32_swap_b32 v100, v101
  s_nop 1
  v_rcp_f32 v100, v100
  s_nop 0
  v_mul_f32 v84, v84, v100
  v_mul_f32 v85, v85, v100
  v_mul_f32 v86, v86, v100
  v_mul_f32 v87, v87, v100
  v_mul_f32 v88, v88, v100
  v_mul_f32 v89, v89, v100
  v_mul_f32 v90, v90, v100
  v_mul_f32 v91, v91, v100
  v_mul_f32 v92, v92, v100
  v_mul_f32 v93, v93, v100
  v_cvt_pk_bf16_f32 v36, v84, v85
  v_cvt_pk_bf16_f32 v37, v86, v87
  v_cvt_pk_bf16_f32 v38, v88, v89
  v_cvt_pk_bf16_f32 v39, v90, v91
  v_cvt_pk_bf16_f32 v40, v92, v93
  ds_write2_b32 v102, v36, v37 offset0:9 offset1:10
  ds_write2_b32 v102, v38, v39 offset0:13 offset1:14
  s_mov_b64 exec, 0xffffffff
  ds_write_b32 v102, v40 offset:68
  s_mov_b64 exec, -1
  s_mul_i32 s3, s21, 36864
  s_bfe_u32 s30, s2, 0x20003
  s_mul_i32 s30, s30, 4608
  s_add_u32 s3, s3, s30
  s_add_u32 s3, s3, 2621440
  v_and_b32 v100, 31, v3
  v_lshrrev_b32 v101, 5, v3
  v_mul_u32_u24 v52, 304, v100
  v_lshl_add_u32 v52, v101, 4, v52
  v_lshrrev_b32 v103, 4, v100
  v_mul_u32_u24 v56, 18432, v103
  v_lshl_add_u32 v56, v101, 8, v56
  v_and_b32 v100, 15, v100
  v_lshl_add_u32 v56, v100, 4, v56
  s_waitcnt lgkmcnt(0)
  s_barrier
  ds_read_b128 v[68:71], v52 offset:38912
  ds_read_b128 v[72:75], v52 offset:39040
  ds_read_b128 v[76:79], v52 offset:39168
  s_waitcnt lgkmcnt(2)
  buffer_store_dwordx4 v[68:71], v56, s[16:19], s3 offen offset:0 sc1
  s_waitcnt lgkmcnt(1)
  buffer_store_dwordx4 v[72:75], v56, s[16:19], s3 offen offset:2048 sc1
  s_add_u32 s31, s3, 4096
  s_cmp_lg_u32 s20, 0
  s_cbranch_scc1 L_osk_4
  s_waitcnt lgkmcnt(0)
  buffer_store_dwordx4 v[76:79], v56, s[16:19], s31 offen offset:0 sc1
L_osk_4:
  s_waitcnt lgkmcnt(0)
  s_barrier
  s_lshl_b32 s3, s21, 8
  s_bfe_u32 s30, s2, 0x20003
  s_lshl_b32 s30, s30, 2
  s_add_u32 s30, s30, s20
  s_lshl_b32 s30, s30, 2
  s_add_u32 s3, s3, s30
  s_add_u32 s3, s3, 14201856
  v_lshlrev_b32 v4, 7, v2
  v_add_u32 v4, s3, v4
  v_mov_b32 v5, 1
  s_mov_b64 exec, 3
  s_waitcnt vmcnt(0)
  global_store_dword v4, v5, s[12:13] sc1
  s_mov_b64 exec, -1
  s_load_dwordx4 s[52:55], s[0:1], 104
  s_lshr_b32 s3, s2, 3
  s_cmp_ge_u32 s3, 30
  s_cbranch_scc1 L_end_k2_kernel
  s_and_b32 s42, s2, 7
  s_mul_i32 s42, s42, 30
  s_add_u32 s42, s42, s3
  s_cmp_ge_u32 s42, 234
  s_cbranch_scc1 L_end_k2_kernel
  s_mul_i32 s40, s42, 7282
  s_lshr_b32 s40, s40, 16
  s_mul_i32 s41, s40, 9
  s_sub_u32 s41, s42, s41
  s_mov_b32 s43, s40
  s_mov_b32 s42, s41
  s_mul_i32 s40, s40, 5
  s_min_u32 s40, s40, 123
  s_lshl_b32 s41, s41, 7
  s_waitcnt lgkmcnt(0)
  s_mov_b32 s44, s52
  s_and_b32 s45, s53, 0xffff
  s_mov_b32 s46, 663552
  s_mov_b32 s47, 0x00020000
  s_mov_b32 s48, s54
  s_and_b32 s49, s55, 0xffff
  s_mov_b32 s50, 4718592
  s_mov_b32 s51, 0x00020000
  s_branch L_oproj
L_loader:
  s_cmp_ge_u32 s2, 256
  s_cbranch_scc1 L_conv
  v_lshlrev_b32 v3, 4, v2
  v_add_u32 v3, 2359296, v3
  s_waitcnt lgkmcnt(0)
  s_mov_b32 s16, s12
  s_and_b32 s17, s13, 0xffff
  s_mov_b32 s18, 16777216
  s_mov_b32 s19, 0x00020000
  s_and_b32 s32, s2, 15
  s_lshl_b32 s32, s32, 10
  s_add_u32 s32, s32, 14155776
  v_lshrrev_b32 v20, 3, v2
  v_lshlrev_b32 v20, 7, v20
  v_and_b32 v22, 7, v2
  v_lshl_add_u32 v20, v22, 3, v20
  v_add_u32 v20, s32, v20
  v_lshlrev_b32 v22, 2, v2
  v_add_u32 v22, 77824, v22
  v_mov_b32 v23, 128
  s_mov_b32 s56, s88
  s_and_b32 s57, s89, 0xffff
  s_mov_b32 s58, 2359296
  s_mov_b32 s59, 0x00020000
  s_mov_b32 s60, s90
  s_and_b32 s61, s91, 0xffff
  s_mov_b32 s62, 663552
  s_mov_b32 s63, 0x00020000
  s_setprio 3
  s_and_b32 s21, s2, 7
  s_lshl_b32 s21, s21, 3
  s_lshr_b32 s3, s2, 5
  s_add_u32 s21, s21, s3
  s_bfe_u32 s22, s2, 0x20003
  s_mul_i32 s28, s22, 288
  s_and_b32 s33, s28, 32
  s_andn2_b32 s28, s28, 63
  s_lshl_b32 s26, s22, 1
  s_add_u32 s26, s26, s3
  s_sub_u32 s3, s26, 9
  s_cmp_ge_u32 s26, 9
  s_cselect_b32 s26, s3, s26
  s_mov_b32 s27, s26
  s_lshl_b32 s24, s20, 10
  s_add_u32 s3, s20, 0
  s_lshl_b32 s3, s3, 6
  v_add_u32 v8, s3, v2
  v_mul_u32_u24 v9, 3277, v8
  v_lshrrev_b32 v9, 16, v9
  v_mul_u32_u24 v10, 20, v9
  v_sub_u32 v10, v8, v10
  v_and_b32 v8, 4, v9
  v_lshrrev_b32 v11, 1, v8
  v_xor_b32 v10, v10, v11
  v_lshlrev_b32 v8, 1, v8
  v_and_b32 v11, 8, v9
  v_lshrrev_b32 v11, 1, v11
  v_and_b32 v9, 0xfffffff3, v9
  v_or3_b32 v9, v9, v8, v11
  v_mul_u32_u24 v4, 1152, v9
  v_lshl_add_u32 v4, v10, 4, v4
  v_add_u32 v4, s28, v4
  s_add_u32 s3, s20, 5
  s_lshl_b32 s3, s3, 6
  v_add_u32 v8, s3, v2
  v_mul_u32_u24 v9, 3277, v8
  v_lshrrev_b32 v9, 16, v9
  v_mul_u32_u24 v10, 20, v9
  v_sub_u32 v10, v8, v10
  v_and_b32 v8, 4, v9
  v_lshrrev_b32 v11, 1, v8
  v_xor_b32 v10, v10, v11
  v_lshlrev_b32 v8, 1, v8
  v_and_b32 v11, 8, v9
  v_lshrrev_b32 v11, 1, v11
  v_and_b32 v9, 0xfffffff3, v9
  v_or3_b32 v9, v9, v8, v11
  v_mul_u32_u24 v5, 1152, v9
  v_lshl_add_u32 v5, v10, 4, v5
  v_add_u32 v5, s28, v5
  s_mul_i32 s29, s26, 73728
  s_add_u32 m0, s24, 0
  s_nop 0
  buffer_load_dwordx4 v4, s[60:63], s29 offen lds
  s_add_u32 m0, s24, 5120
  s_nop 0
  buffer_load_dwordx4 v5, s[60:63], s29 offen lds
  s_add_u32 s29, s29, 36864
  s_add_u32 s26, s26, 1
  s_cmp_eq_u32 s26, 9
  s_cselect_b32 s26, 0, s26
  s_add_u32 m0, s24, 10240
  s_nop 0
  buffer_load_dwordx4 v4, s[60:63], s29 offen lds
  s_add_u32 m0, s24, 15360
  s_nop 0
  buffer_load_dwordx4 v5, s[60:63], s29 offen lds
  s_mul_i32 s29, s26, 73728
  s_add_u32 m0, s24, 20480
  s_nop 0
  buffer_load_dwordx4 v4, s[60:63], s29 offen lds
  s_add_u32 m0, s24, 25600
  s_nop 0
  buffer_load_dwordx4 v5, s[60:63], s29 offen lds
  s_add_u32 s29, s29, 36864
  s_add_u32 s26, s26, 1
  s_cmp_eq_u32 s26, 9
  s_cselect_b32 s26, 0, s26
  s_add_u32 m0, s24, 30720
  s_nop 0
  buffer_load_dwordx4 v4, s[60:63], s29 offen lds
  s_add_u32 m0, s24, 35840
  s_nop 0
  buffer_load_dwordx4 v5, s[60:63], s29 offen lds
  s_mul_i32 s29, s26, 73728
  s_add_u32 m0, s24, 40960
  s_nop 0
  buffer_load_dwordx4 v4, s[60:63], s29 offen lds
  s_add_u32 m0, s24, 46080
  s_nop 0
  buffer_load_dwordx4 v5, s[60:63], s29 offen lds
  s_add_u32 s29, s29, 36864
  s_add_u32 s26, s26, 1
  s_cmp_eq_u32 s26, 9
  s_cselect_b32 s26, 0, s26
  s_add_u32 m0, s24, 51200
  s_nop 0
  buffer_load_dwordx4 v4, s[60:63], s29 offen lds
  s_add_u32 m0, s24, 56320
  s_nop 0
  buffer_load_dwordx4 v5, s[60:63], s29 offen lds
  s_waitcnt vmcnt(8)
  s_barrier
  s_waitcnt vmcnt(4)
  s_barrier
  s_mul_i32 s29, s26, 73728
  s_add_u32 m0, s24, 0
  s_nop 0
  buffer_load_dwordx4 v4, s[60:63], s29 offen lds
  s_add_u32 m0, s24, 5120
  s_nop 0
  buffer_load_dwordx4 v5, s[60:63], s29 offen lds
  s_add_u32 s29, s29, 36864
  s_add_u32 s26, s26, 1
  s_cmp_eq_u32 s26, 9
  s_cselect_b32 s26, 0, s26
  s_add_u32 m0, s24, 10240
  s_nop 0
  buffer_load_dwordx4 v4, s[60:63], s29 offen lds
  s_add_u32 m0, s24, 15360
  s_nop 0
  buffer_load_dwordx4 v5, s[60:63], s29 offen lds
  s_waitcnt vmcnt(4)
  s_barrier
  s_mul_i32 s29, s26, 73728
  s_add_u32 m0, s24, 20480
  s_nop 0
  buffer_load_dwordx4 v4, s[60:63], s29 offen lds
  s_add_u32 m0, s24, 25600
  s_nop 0
  buffer_load_dwordx4 v5, s[60:63], s29 offen lds
  s_add_u32 s29, s29, 36864
  s_add_u32 s26, s26, 1
  s_cmp_eq_u32 s26, 9
  s_cselect_b32 s26, 0, s26
  s_add_u32 m0, s24, 30720
  s_nop 0
  buffer_load_dwordx4 v4, s[60:63], s29 offen lds
  s_add_u32 m0, s24, 35840
  s_nop 0
  buffer_load_dwordx4 v5, s[60:63], s29 offen lds
  s_waitcnt vmcnt(4)
  s_barrier
  s_mul_i32 s29, s26, 73728
  s_add_u32 m0, s24, 40960
  s_nop 0
  buffer_load_dwordx4 v4, s[60:63], s29 offen lds
  s_add_u32 m0, s24, 46080
  s_nop 0
  buffer_load_dwordx4 v5, s[60:63], s29 offen lds
  s_add_u32 s29, s29, 36864
  s_add_u32 s26, s26, 1
  s_cmp_eq_u32 s26, 9
  s_cselect_b32 s26, 0, s26
  s_add_u32 m0, s24, 51200
  s_nop 0
  buffer_load_dwordx4 v4, s[60:63], s29 offen lds
  s_add_u32 m0, s24, 56320
  s_nop 0
  buffer_load_dwordx4 v5, s[60:63], s29 offen lds
  s_waitcnt vmcnt(4)
  s_barrier
  s_mul_i32 s29, s26, 73728
  s_add_u32 m0, s24, 0
  s_nop 0
  buffer_load_dwordx4 v4, s[60:63], s29 offen lds
  s_add_u32 m0, s24, 5120
  s_nop 0
  buffer_load_dwordx4 v5, s[60:63], s29 offen lds
  s_add_u32 s29, s29, 36864
  s_add_u32 s26, s26, 1
  s_cmp_eq_u32 s26, 9
  s_cselect_b32 s26, 0, s26
  s_add_u32 m0, s24, 10240
  s_nop 0
  buffer_load_dwordx4 v4, s[60:63], s29 offen lds
  s_add_u32 m0, s24, 15360
  s_nop 0
  buffer_load_dwordx4 v5, s[60:63], s29 offen lds
  s_waitcnt vmcnt(4)
  s_barrier
  s_mul_i32 s29, s26, 73728
  s_add_u32 m0, s24, 20480
  s_nop 0
  buffer_load_dwordx4 v4, s[60:63], s29 offen lds
  s_add_u32 m0, s24, 25600
  s_nop 0
  buffer_load_dwordx4 v5, s[60:63], s29 offen lds
  s_add_u32 s29, s29, 36864
  s_add_u32 s26, s26, 1
  s_cmp_eq_u32 s26, 9
  s_cselect_b32 s26, 0, s26
  s_add_u32 m0, s24, 30720
  s_nop 0
  buffer_load_dwordx4 v4, s[60:63], s29 offen lds
  s_add_u32 m0, s24, 35840
  s_nop 0
  buffer_load_dwordx4 v5, s[60:63], s29 offen lds
  s_waitcnt vmcnt(4)
  s_barrier
  s_mul_i32 s29, s26, 73728
  s_add_u32 m0, s24, 40960
  s_nop 0
  buffer_load_dwordx4 v4, s[60:63], s29 offen lds
  s_add_u32 m0, s24, 46080
  s_nop 0
  buffer_load_dwordx4 v5, s[60:63], s29 offen lds
  s_add_u32 s29, s29, 36864
  s_add_u32 s26, s26, 1
  s_cmp_eq_u32 s26, 9
  s_cselect_b32 s26, 0, s26
  s_add_u32 m0, s24, 51200
  s_nop 0
  buffer_load_dwordx4 v4, s[60:63], s29 offen lds
  s_add_u32 m0, s24, 56320
  s_nop 0
  buffer_load_dwordx4 v5, s[60:63], s29 offen lds
  s_waitcnt vmcnt(4)
  s_barrier
  global_load_dword v24, v23, s[14:15]
  s_waitcnt vmcnt(1)
  s_barrier
  s_waitcnt vmcnt(0)
  s_branch L_ldslow_5
  s_barrier
  s_barrier
  s_branch L_ldjoin_6
L_ldslow_5:
  global_load_dwordx2 v[26:27], v20, s[12:13] sc1
  s_barrier
  s_barrier
  s_waitcnt vmcnt(0)
  v_min3_u32 v25, v24, v26, v27
  v_cmp_eq_u32 vcc, 0, v25
  v_readfirstlane_b32 s3, v24
  s_nop 3
  s_cmp_eq_u64 vcc, 0
  s_cbranch_scc1 L_lds3_8
  s_cmp_lg_u32 s3, 0
  s_cbranch_scc1 L_lds2_7
  s_mov_b32 s31, 0x10000
L_pl_9:
  global_load_dword v24, v23, s[14:15] sc1
  s_waitcnt vmcnt(0)
  v_cmp_eq_u32 vcc, 0, v24
  s_sub_u32 s31, s31, 1
  s_cbranch_scc1 L_pd_10
  s_nop 2
  s_cmp_eq_u64 vcc, 0
  s_cbranch_scc1 L_pd_10
  s_sleep 8
  s_branch L_pl_9
L_pd_10:
L_lds2_7:
  s_mov_b32 s31, 0x10000
L_pl_11:
  global_load_dwordx2 v[26:27], v20, s[12:13] sc1
  s_waitcnt vmcnt(0)
  v_min_u32 v25, v26, v27
  v_cmp_eq_u32 vcc, 0, v25
  s_sub_u32 s31, s31, 1
  s_cbranch_scc1 L_pd_12
  s_nop 2
  s_cmp_eq_u64 vcc, 0
  s_cbranch_scc1 L_pd_12
  s_sleep 12
  s_branch L_pl_11
L_pd_12:
L_lds3_8:
  ds_write_b32 v22, v26
  s_mov_b32 m0, 0
  s_mov_b32 s30, 0
  buffer_load_dwordx4 v3, s[16:19], s30 offen offset:0 sc1 lds
  buffer_load_dwordx4 v3, s[16:19], s30 offen offset:1024 sc1 lds
  buffer_load_dwordx4 v3, s[16:19], s30 offen offset:2048 sc1 lds
  buffer_load_dwordx4 v3, s[16:19], s30 offen offset:3072 sc1 lds
  s_mov_b32 m0, 4096
  s_mov_b32 s30, 4096
  buffer_load_dwordx4 v3, s[16:19], s30 offen offset:0 sc1 lds
  buffer_load_dwordx4 v3, s[16:19], s30 offen offset:1024 sc1 lds
  buffer_load_dwordx4 v3, s[16:19], s30 offen offset:2048 sc1 lds
  buffer_load_dwordx4 v3, s[16:19], s30 offen offset:3072 sc1 lds
  s_mov_b32 m0, 8192
  s_mov_b32 s30, 8192
  buffer_load_dwordx4 v3, s[16:19], s30 offen offset:0 sc1 lds
  buffer_load_dwordx4 v3, s[16:19], s30 offen offset:1024 sc1 lds
  buffer_load_dwordx4 v3, s[16:19], s30 offen offset:2048 sc1 lds
  buffer_load_dwordx4 v3, s[16:19], s30 offen offset:3072 sc1 lds
  s_mov_b32 m0, 12288
  s_mov_b32 s30, 12288
  buffer_load_dwordx4 v3, s[16:19], s30 offen offset:0 sc1 lds
  buffer_load_dwordx4 v3, s[16:19], s30 offen offset:1024 sc1 lds
  buffer_load_dwordx4 v3, s[16:19], s30 offen offset:2048 sc1 lds
  buffer_load_dwordx4 v3, s[16:19], s30 offen offset:3072 sc1 lds
  s_mov_b32 m0, 16384
  s_mov_b32 s30, 16384
  buffer_load_dwordx4 v3, s[16:19], s30 offen offset:0 sc1 lds
  buffer_load_dwordx4 v3, s[16:19], s30 offen offset:1024 sc1 lds
  buffer_load_dwordx4 v3, s[16:19], s30 offen offset:2048 sc1 lds
L_ldjoin_6:
  s_setprio 1
  s_waitcnt lgkmcnt(0)
  s_barrier
  s_waitcnt vmcnt(0)
  s_barrier
  s_mov_b32 m0, 19456
  s_mov_b32 s30, 19456
  buffer_load_dwordx4 v3, s[16:19], s30 offen offset:0 sc1 lds
  buffer_load_dwordx4 v3, s[16:19], s30 offen offset:1024 sc1 lds
  buffer_load_dwordx4 v3, s[16:19], s30 offen offset:2048 sc1 lds
  buffer_load_dwordx4 v3, s[16:19], s30 offen offset:3072 sc1 lds
  s_mov_b32 m0, 23552
  s_mov_b32 s30, 23552
  buffer_load_dwordx4 v3, s[16:19], s30 offen offset:0 sc1 lds
  buffer_load_dwordx4 v3, s[16:19], s30 offen offset:1024 sc1 lds
  buffer_load_dwordx4 v3, s[16:19], s30 offen offset:2048 sc1 lds
  buffer_load_dwordx4 v3, s[16:19], s30 offen offset:3072 sc1 lds
  s_mov_b32 m0, 27648
  s_mov_b32 s30, 27648
  buffer_load_dwordx4 v3, s[16:19], s30 offen offset:0 sc1 lds
  buffer_load_dwordx4 v3, s[16:19], s30 offen offset:1024 sc1 lds
  buffer_load_dwordx4 v3, s[16:19], s30 offen offset:2048 sc1 lds
  buffer_load_dwordx4 v3, s[16:19], s30 offen offset:3072 sc1 lds
  s_mov_b32 m0, 31744
  s_mov_b32 s30, 31744
  buffer_load_dwordx4 v3, s[16:19], s30 offen offset:0 sc1 lds
  buffer_load_dwordx4 v3, s[16:19], s30 offen offset:1024 sc1 lds
  buffer_load_dwordx4 v3, s[16:19], s30 offen offset:2048 sc1 lds
  buffer_load_dwordx4 v3, s[16:19], s30 offen offset:3072 sc1 lds
  s_mov_b32 m0, 35840
  s_mov_b32 s30, 35840
  buffer_load_dwordx4 v3, s[16:19], s30 offen offset:0 sc1 lds
  buffer_load_dwordx4 v3, s[16:19], s30 offen offset:1024 sc1 lds
  buffer_load_dwordx4 v3, s[16:19], s30 offen offset:2048 sc1 lds
  s_mov_b32 m0, 38912
  s_mov_b32 s30, 38912
  buffer_load_dwordx4 v3, s[16:19], s30 offen offset:0 sc1 lds
  buffer_load_dwordx4 v3, s[16:19], s30 offen offset:1024 sc1 lds
  buffer_load_dwordx4 v3, s[16:19], s30 offen offset:2048 sc1 lds
  buffer_load_dwordx4 v3, s[16:19], s30 offen offset:3072 sc1 lds
  s_mov_b32 m0, 43008
  s_mov_b32 s30, 43008
  buffer_load_dwordx4 v3, s[16:19], s30 offen offset:0 sc1 lds
  buffer_load_dwordx4 v3, s[16:19], s30 offen offset:1024 sc1 lds
  buffer_load_dwordx4 v3, s[16:19], s30 offen offset:2048 sc1 lds
  buffer_load_dwordx4 v3, s[16:19], s30 offen offset:3072 sc1 lds
  s_mov_b32 m0, 47104
  s_mov_b32 s30, 47104
  buffer_load_dwordx4 v3, s[16:19], s30 offen offset:0 sc1 lds
  buffer_load_dwordx4 v3, s[16:19], s30 offen offset:1024 sc1 lds
  buffer_load_dwordx4 v3, s[16:19], s30 offen offset:2048 sc1 lds
  buffer_load_dwordx4 v3, s[16:19], s30 offen offset:3072 sc1 lds
  s_mov_b32 m0, 51200
  s_mov_b32 s30, 51200
  buffer_load_dwordx4 v3, s[16:19], s30 offen offset:0 sc1 lds
  buffer_load_dwordx4 v3, s[16:19], s30 offen offset:1024 sc1 lds
  buffer_load_dwordx4 v3, s[16:19], s30 offen offset:2048 sc1 lds
  buffer_load_dwordx4 v3, s[16:19], s30 offen offset:3072 sc1 lds
  s_mov_b32 m0, 55296
  s_mov_b32 s30, 55296
  buffer_load_dwordx4 v3, s[16:19], s30 offen offset:0 sc1 lds
  buffer_load_dwordx4 v3, s[16:19], s30 offen offset:1024 sc1 lds
  buffer_load_dwordx4 v3, s[16:19], s30 offen offset:2048 sc1 lds
  s_mov_b32 m0, 58368
  s_mov_b32 s30, 58368
  buffer_load_dwordx4 v3, s[16:19], s30 offen offset:0 sc1 lds
  buffer_load_dwordx4 v3, s[16:19], s30 offen offset:1024 sc1 lds
  buffer_load_dwordx4 v3, s[16:19], s30 offen offset:2048 sc1 lds
  buffer_load_dwordx4 v3, s[16:19], s30 offen offset:3072 sc1 lds
  s_mov_b32 m0, 62464
  s_mov_b32 s30, 62464
  buffer_load_dwordx4 v3, s[16:19], s30 offen offset:0 sc1 lds
  buffer_load_dwordx4 v3, s[16:19], s30 offen offset:1024 sc1 lds
  buffer_load_dwordx4 v3, s[16:19], s30 offen offset:2048 sc1 lds
  buffer_load_dwordx4 v3, s[16:19], s30 offen offset:3072 sc1 lds
  s_mov_b32 m0, 66560
  s_mov_b32 s30, 66560
  buffer_load_dwordx4 v3, s[16:19], s30 offen offset:0 sc1 lds
  buffer_load_dwordx4 v3, s[16:19], s30 offen offset:1024 sc1 lds
  buffer_load_dwordx4 v3, s[16:19], s30 offen offset:2048 sc1 lds
  buffer_load_dwordx4 v3, s[16:19], s30 offen offset:3072 sc1 lds
  s_mov_b32 m0, 70656
  s_mov_b32 s30, 70656
  buffer_load_dwordx4 v3, s[16:19], s30 offen offset:0 sc1 lds
  buffer_load_dwordx4 v3, s[16:19], s30 offen offset:1024 sc1 lds
  buffer_load_dwordx4 v3, s[16:19], s30 offen offset:2048 sc1 lds
  buffer_load_dwordx4 v3, s[16:19], s30 offen offset:3072 sc1 lds
  s_mov_b32 m0, 74752
  s_mov_b32 s30, 74752
  buffer_load_dwordx4 v3, s[16:19], s30 offen offset:0 sc1 lds
  buffer_load_dwordx4 v3, s[16:19], s30 offen offset:1024 sc1 lds
  buffer_load_dwordx4 v3, s[16:19], s30 offen offset:2048 sc1 lds
  s_waitcnt vmcnt(38)
  s_barrier
  s_waitcnt vmcnt(19)
  s_barrier
  s_mov_b32 m0, 0
  s_mov_b32 s30, 77824
  buffer_load_dwordx4 v3, s[16:19], s30 offen offset:0 sc1 lds
  buffer_load_dwordx4 v3, s[16:19], s30 offen offset:1024 sc1 lds
  buffer_load_dwordx4 v3, s[16:19], s30 offen offset:2048 sc1 lds
  buffer_load_dwordx4 v3, s[16:19], s30 offen offset:3072 sc1 lds
  s_mov_b32 m0, 4096
  s_mov_b32 s30, 81920
  buffer_load_dwordx4 v3, s[16:19], s30 offen offset:0 sc1 lds
  buffer_load_dwordx4 v3, s[16:19], s30 offen offset:1024 sc1 lds
  buffer_load_dwordx4 v3, s[16:19], s30 offen offset:2048 sc1 lds
  buffer_load_dwordx4 v3, s[16:19], s30 offen offset:3072 sc1 lds
  s_mov_b32 m0, 8192
  s_mov_b32 s30, 86016
  buffer_load_dwordx4 v3, s[16:19], s30 offen offset:0 sc1 lds
  buffer_load_dwordx4 v3, s[16:19], s30 offen offset:1024 sc1 lds
  buffer_load_dwordx4 v3, s[16:19], s30 offen offset:2048 sc1 lds
  buffer_load_dwordx4 v3, s[16:19], s30 offen offset:3072 sc1 lds
  s_mov_b32 m0, 12288
  s_mov_b32 s30, 90112
  buffer_load_dwordx4 v3, s[16:19], s30 offen offset:0 sc1 lds
  buffer_load_dwordx4 v3, s[16:19], s30 offen offset:1024 sc1 lds
  buffer_load_dwordx4 v3, s[16:19], s30 offen offset:2048 sc1 lds
  buffer_load_dwordx4 v3, s[16:19], s30 offen offset:3072 sc1 lds
  s_mov_b32 m0, 16384
  s_mov_b32 s30, 94208
  buffer_load_dwordx4 v3, s[16:19], s30 offen offset:0 sc1 lds
  buffer_load_dwordx4 v3, s[16:19], s30 offen offset:1024 sc1 lds
  buffer_load_dwordx4 v3, s[16:19], s30 offen offset:2048 sc1 lds
  s_waitcnt vmcnt(19)
  s_barrier
  s_mov_b32 m0, 19456
  s_mov_b32 s30, 97280
  buffer_load_dwordx4 v3, s[16:19], s30 offen offset:0 sc1 lds
  buffer_load_dwordx4 v3, s[16:19], s30 offen offset:1024 sc1 lds
  buffer_load_dwordx4 v3, s[16:19], s30 offen offset:2048 sc1 lds
  buffer_load_dwordx4 v3, s[16:19], s30 offen offset:3072 sc1 lds
  s_mov_b32 m0, 23552
  s_mov_b32 s30, 101376
  buffer_load_dwordx4 v3, s[16:19], s30 offen offset:0 sc1 lds
  buffer_load_dwordx4 v3, s[16:19], s30 offen offset:1024 sc1 lds
  buffer_load_dwordx4 v3, s[16:19], s30 offen offset:2048 sc1 lds
  buffer_load_dwordx4 v3, s[16:19], s30 offen offset:3072 sc1 lds
  s_mov_b32 m0, 27648
  s_mov_b32 s30, 105472
  buffer_load_dwordx4 v3, s[16:19], s30 offen offset:0 sc1 lds
  buffer_load_dwordx4 v3, s[16:19], s30 offen offset:1024 sc1 lds
  buffer_load_dwordx4 v3, s[16:19], s30 offen offset:2048 sc1 lds
  buffer_load_dwordx4 v3, s[16:19], s30 offen offset:3072 sc1 lds
  s_mov_b32 m0, 31744
  s_mov_b32 s30, 109568
  buffer_load_dwordx4 v3, s[16:19], s30 offen offset:0 sc1 lds
  buffer_load_dwordx4 v3, s[16:19], s30 offen offset:1024 sc1 lds
  buffer_load_dwordx4 v3, s[16:19], s30 offen offset:2048 sc1 lds
  buffer_load_dwordx4 v3, s[16:19], s30 offen offset:3072 sc1 lds
  s_mov_b32 m0, 35840
  s_mov_b32 s30, 113664
  buffer_load_dwordx4 v3, s[16:19], s30 offen offset:0 sc1 lds
  buffer_load_dwordx4 v3, s[16:19], s30 offen offset:1024 sc1 lds
  buffer_load_dwordx4 v3, s[16:19], s30 offen offset:2048 sc1 lds
  s_waitcnt vmcnt(19)
  s_barrier
  s_mov_b32 m0, 38912
  s_mov_b32 s30, 116736
  buffer_load_dwordx4 v3, s[16:19], s30 offen offset:0 sc1 lds
  buffer_load_dwordx4 v3, s[16:19], s30 offen offset:1024 sc1 lds
  buffer_load_dwordx4 v3, s[16:19], s30 offen offset:2048 sc1 lds
  buffer_load_dwordx4 v3, s[16:19], s30 offen offset:3072 sc1 lds
  s_mov_b32 m0, 43008
  s_mov_b32 s30, 120832
  buffer_load_dwordx4 v3, s[16:19], s30 offen offset:0 sc1 lds
  buffer_load_dwordx4 v3, s[16:19], s30 offen offset:1024 sc1 lds
  buffer_load_dwordx4 v3, s[16:19], s30 offen offset:2048 sc1 lds
  buffer_load_dwordx4 v3, s[16:19], s30 offen offset:3072 sc1 lds
  s_mov_b32 m0, 47104
  s_mov_b32 s30, 124928
  buffer_load_dwordx4 v3, s[16:19], s30 offen offset:0 sc1 lds
  buffer_load_dwordx4 v3, s[16:19], s30 offen offset:1024 sc1 lds
  buffer_load_dwordx4 v3, s[16:19], s30 offen offset:2048 sc1 lds
  buffer_load_dwordx4 v3, s[16:19], s30 offen offset:3072 sc1 lds
  s_mov_b32 m0, 51200
  s_mov_b32 s30, 129024
  buffer_load_dwordx4 v3, s[16:19], s30 offen offset:0 sc1 lds
  buffer_load_dwordx4 v3, s[16:19], s30 offen offset:1024 sc1 lds
  buffer_load_dwordx4 v3, s[16:19], s30 offen offset:2048 sc1 lds
  buffer_load_dwordx4 v3, s[16:19], s30 offen offset:3072 sc1 lds
  s_mov_b32 m0, 55296
  s_mov_b32 s30, 133120
  buffer_load_dwordx4 v3, s[16:19], s30 offen offset:0 sc1 lds
  buffer_load_dwordx4 v3, s[16:19], s30 offen offset:1024 sc1 lds
  buffer_load_dwordx4 v3, s[16:19], s30 offen offset:2048 sc1 lds
  s_waitcnt vmcnt(19)
  s_barrier
  s_mov_b32 m0, 58368
  s_mov_b32 s30, 136192
  buffer_load_dwordx4 v3, s[16:19], s30 offen offset:0 sc1 lds
  buffer_load_dwordx4 v3, s[16:19], s30 offen offset:1024 sc1 lds
  buffer_load_dwordx4 v3, s[16:19], s30 offen offset:2048 sc1 lds
  buffer_load_dwordx4 v3, s[16:19], s30 offen offset:3072 sc1 lds
  s_mov_b32 m0, 62464
  s_mov_b32 s30, 140288
  buffer_load_dwordx4 v3, s[16:19], s30 offen offset:0 sc1 lds
  buffer_load_dwordx4 v3, s[16:19], s30 offen offset:1024 sc1 lds
  buffer_load_dwordx4 v3, s[16:19], s30 offen offset:2048 sc1 lds
  buffer_load_dwordx4 v3, s[16:19], s30 offen offset:3072 sc1 lds
  s_mov_b32 m0, 66560
  s_mov_b32 s30, 144384
  buffer_load_dwordx4 v3, s[16:19], s30 offen offset:0 sc1 lds
  buffer_load_dwordx4 v3, s[16:19], s30 offen offset:1024 sc1 lds
  buffer_load_dwordx4 v3, s[16:19], s30 offen offset:2048 sc1 lds
  buffer_load_dwordx4 v3, s[16:19], s30 offen offset:3072 sc1 lds
  s_mov_b32 m0, 70656
  s_mov_b32 s30, 148480
  buffer_load_dwordx4 v3, s[16:19], s30 offen offset:0 sc1 lds
  buffer_load_dwordx4 v3, s[16:19], s30 offen offset:1024 sc1 lds
  buffer_load_dwordx4 v3, s[16:19], s30 offen offset:2048 sc1 lds
  buffer_load_dwordx4 v3, s[16:19], s30 offen offset:3072 sc1 lds
  s_mov_b32 m0, 74752
  s_mov_b32 s30, 152576
  buffer_load_dwordx4 v3, s[16:19], s30 offen offset:0 sc1 lds
  buffer_load_dwordx4 v3, s[16:19], s30 offen offset:1024 sc1 lds
  buffer_load_dwordx4 v3, s[16:19], s30 offen offset:2048 sc1 lds
  s_load_dwordx4 s[52:55], s[0:1], 104
  s_lshr_b32 s3, s2, 3
  s_cmp_ge_u32 s3, 30
  s_cbranch_scc1 L_ld_notask
  s_and_b32 s42, s2, 7
  s_mul_i32 s42, s42, 30
  s_add_u32 s42, s42, s3
  s_cmp_ge_u32 s42, 234
  s_cbranch_scc1 L_ld_notask
  s_mul_i32 s40, s42, 7282
  s_lshr_b32 s40, s40, 16
  s_mul_i32 s41, s40, 9
  s_sub_u32 s41, s42, s41
  s_mov_b32 s43, s40
  s_mov_b32 s42, s41
  s_mul_i32 s40, s40, 5
  s_min_u32 s40, s40, 123
  s_lshl_b32 s41, s41, 7
  s_waitcnt lgkmcnt(0)
  s_mov_b32 s44, s52
  s_and_b32 s45, s53, 0xffff
  s_mov_b32 s46, 663552
  s_mov_b32 s47, 0x00020000
  s_mov_b32 s48, s54
  s_and_b32 s49, s55, 0xffff
  s_mov_b32 s50, 4718592
  s_mov_b32 s51, 0x00020000
  v_lshrrev_b32 v6, 3, v2
  v_and_b32 v7, 7, v2
  v_and_b32 v8, 2, v6
  v_xor_b32 v7, v7, v8
  v_mul_u32_u24 v4, 1152, v6
  v_add_u32 v4, s41, v4
  v_xor_b32 v8, 4, v7
  v_lshl_add_u32 v5, v8, 4, v4
  v_lshl_add_u32 v4, v7, 4, v4
  s_waitcnt vmcnt(19)
  s_barrier
  s_mov_b32 m0, 0
  s_mov_b32 s30, 0
  buffer_load_dwordx4 v4, s[44:47], s30 offen lds
  s_mov_b32 m0, 1024
  s_mov_b32 s30, 9216
  buffer_load_dwordx4 v5, s[44:47], s30 offen lds
  s_mov_b32 m0, 2048
  s_mov_b32 s30, 18432
  buffer_load_dwordx4 v4, s[44:47], s30 offen lds
  s_mov_b32 m0, 3072
  s_mov_b32 s30, 27648
  buffer_load_dwordx4 v5, s[44:47], s30 offen lds
  s_mov_b32 m0, 4096
  s_mov_b32 s30, 36864
  buffer_load_dwordx4 v4, s[44:47], s30 offen lds
  s_mov_b32 m0, 5120
  s_mov_b32 s30, 46080
  buffer_load_dwordx4 v5, s[44:47], s30 offen lds
  s_mov_b32 m0, 6144
  s_mov_b32 s30, 55296
  buffer_load_dwordx4 v4, s[44:47], s30 offen lds
  s_mov_b32 m0, 7168
  s_mov_b32 s30, 64512
  buffer_load_dwordx4 v5, s[44:47], s30 offen lds
  s_mov_b32 m0, 8192
  s_mov_b32 s30, 73728
  buffer_load_dwordx4 v4, s[44:47], s30 offen lds
  s_mov_b32 m0, 9216
  s_mov_b32 s30, 82944
  buffer_load_dwordx4 v5, s[44:47], s30 offen lds
  s_mov_b32 m0, 10240
  s_mov_b32 s30, 92160
  buffer_load_dwordx4 v4, s[44:47], s30 offen lds
  s_mov_b32 m0, 11264
  s_mov_b32 s30, 101376
  buffer_load_dwordx4 v5, s[44:47], s30 offen lds
  s_mov_b32 m0, 12288
  s_mov_b32 s30, 110592
  buffer_load_dwordx4 v4, s[44:47], s30 offen lds
  s_mov_b32 m0, 13312
  s_mov_b32 s30, 119808
  buffer_load_dwordx4 v5, s[44:47], s30 offen lds
  s_mov_b32 m0, 14336
  s_mov_b32 s30, 129024
  buffer_load_dwordx4 v4, s[44:47], s30 offen lds
  s_mov_b32 m0, 15360
  s_mov_b32 s30, 138240
  buffer_load_dwordx4 v5, s[44:47], s30 offen lds
  s_mov_b32 m0, 16384
  s_mov_b32 s30, 147456
  buffer_load_dwordx4 v4, s[44:47], s30 offen lds
  s_mov_b32 m0, 17408
  s_mov_b32 s30, 156672
  buffer_load_dwordx4 v5, s[44:47], s30 offen lds
  s_mov_b32 m0, 18432
  s_mov_b32 s30, 165888
  buffer_load_dwordx4 v4, s[44:47], s30 offen lds
  v_mov_b32 v20, 132
  global_load_dword v21, v20, s[14:15]
  s_waitcnt vmcnt(0)
  v_readfirstlane_b32 s31, v21
  s_nop 3
  s_cmp_lg_u32 s31, 0
  s_cbranch_scc1 L_rdy_13
  s_sleep 12
  s_mov_b32 s31, 0x10000
L_pl_14:
  global_load_dword v21, v20, s[14:15] sc1
  s_waitcnt vmcnt(0)
  v_cmp_eq_u32 vcc, 0, v21
  s_sub_u32 s31, s31, 1
  s_cbranch_scc1 L_pd_15
  s_nop 2
  s_cmp_eq_u64 vcc, 0
  s_cbranch_scc1 L_pd_15
  s_sleep 12
  s_branch L_pl_14
L_pd_15:
L_rdy_13:
  s_waitcnt vmcnt(19)
  s_barrier
  s_mov_b32 m0, 19456
  s_mov_b32 s30, 175104
  buffer_load_dwordx4 v5, s[44:47], s30 offen lds
  s_mov_b32 m0, 20480
  s_mov_b32 s30, 184320
  buffer_load_dwordx4 v4, s[44:47], s30 offen lds
  s_mov_b32 m0, 21504
  s_mov_b32 s30, 193536
  buffer_load_dwordx4 v5, s[44:47], s30 offen lds
  s_mov_b32 m0, 22528
  s_mov_b32 s30, 202752
  buffer_load_dwordx4 v4, s[44:47], s30 offen lds
  s_mov_b32 m0, 23552
  s_mov_b32 s30, 211968
  buffer_load_dwordx4 v5, s[44:47], s30 offen lds
  s_mov_b32 m0, 24576
  s_mov_b32 s30, 221184
  buffer_load_dwordx4 v4, s[44:47], s30 offen lds
  s_mov_b32 m0, 25600
  s_mov_b32 s30, 230400
  buffer_load_dwordx4 v5, s[44:47], s30 offen lds
  s_mov_b32 m0, 26624
  s_mov_b32 s30, 239616
  buffer_load_dwordx4 v4, s[44:47], s30 offen lds
  s_mov_b32 m0, 27648
  s_mov_b32 s30, 248832
  buffer_load_dwordx4 v5, s[44:47], s30 offen lds
  s_mov_b32 m0, 28672
  s_mov_b32 s30, 258048
  buffer_load_dwordx4 v4, s[44:47], s30 offen lds
  s_mov_b32 m0, 29696
  s_mov_b32 s30, 267264
  buffer_load_dwordx4 v5, s[44:47], s30 offen lds
  s_mov_b32 m0, 30720
  s_mov_b32 s30, 276480
  buffer_load_dwordx4 v4, s[44:47], s30 offen lds
  s_mov_b32 m0, 31744
  s_mov_b32 s30, 285696
  buffer_load_dwordx4 v5, s[44:47], s30 offen lds
  s_mov_b32 m0, 32768
  s_mov_b32 s30, 294912
  buffer_load_dwordx4 v4, s[44:47], s30 offen lds
  s_mov_b32 m0, 33792
  s_mov_b32 s30, 304128
  buffer_load_dwordx4 v5, s[44:47], s30 offen lds
  s_mov_b32 m0, 34816
  s_mov_b32 s30, 313344
  buffer_load_dwordx4 v4, s[44:47], s30 offen lds
  s_mov_b32 m0, 35840
  s_mov_b32 s30, 322560
  buffer_load_dwordx4 v5, s[44:47], s30 offen lds
  s_mov_b32 m0, 36864
  s_mov_b32 s30, 331776
  buffer_load_dwordx4 v4, s[44:47], s30 offen lds
  s_mov_b32 m0, 37888
  s_mov_b32 s30, 340992
  buffer_load_dwordx4 v5, s[44:47], s30 offen lds
  s_waitcnt vmcnt(38)
  s_barrier
  s_mov_b32 m0, 49152
  s_mov_b32 s30, 442368
  buffer_load_dwordx4 v4, s[44:47], s30 offen lds
  s_mov_b32 m0, 50176
  s_mov_b32 s30, 451584
  buffer_load_dwordx4 v5, s[44:47], s30 offen lds
  s_mov_b32 m0, 51200
  s_mov_b32 s30, 460800
  buffer_load_dwordx4 v4, s[44:47], s30 offen lds
  s_mov_b32 m0, 52224
  s_mov_b32 s30, 470016
  buffer_load_dwordx4 v5, s[44:47], s30 offen lds
  s_mov_b32 m0, 53248
  s_mov_b32 s30, 479232
  buffer_load_dwordx4 v4, s[44:47], s30 offen lds
  s_mov_b32 m0, 54272
  s_mov_b32 s30, 488448
  buffer_load_dwordx4 v5, s[44:47], s30 offen lds
  s_mov_b32 m0, 55296
  s_mov_b32 s30, 497664
  buffer_load_dwordx4 v4, s[44:47], s30 offen lds
  s_mov_b32 m0, 56320
  s_mov_b32 s30, 506880
  buffer_load_dwordx4 v5, s[44:47], s30 offen lds
  s_mov_b32 m0, 57344
  s_mov_b32 s30, 516096
  buffer_load_dwordx4 v4, s[44:47], s30 offen lds
  s_setprio 3
  s_barrier
  s_mov_b32 m0, 58368
  s_mov_b32 s30, 525312
  buffer_load_dwordx4 v5, s[44:47], s30 offen lds
  s_mov_b32 m0, 59392
  s_mov_b32 s30, 534528
  buffer_load_dwordx4 v4, s[44:47], s30 offen lds
  s_mov_b32 m0, 60416
  s_mov_b32 s30, 543744
  buffer_load_dwordx4 v5, s[44:47], s30 offen lds
  s_mov_b32 m0, 61440
  s_mov_b32 s30, 552960
  buffer_load_dwordx4 v4, s[44:47], s30 offen lds
  s_mov_b32 m0, 62464
  s_mov_b32 s30, 562176
  buffer_load_dwordx4 v5, s[44:47], s30 offen lds
  s_mov_b32 m0, 63488
  s_mov_b32 s30, 571392
  buffer_load_dwordx4 v4, s[44:47], s30 offen lds
  s_mov_b32 m0, 64512
  s_mov_b32 s30, 580608
  buffer_load_dwordx4 v5, s[44:47], s30 offen lds
  s_mov_b32 m0, 65536
  s_mov_b32 s30, 589824
  buffer_load_dwordx4 v4, s[44:47], s30 offen lds
  s_mov_b32 m0, 66560
  s_mov_b32 s30, 599040
  buffer_load_dwordx4 v5, s[44:47], s30 offen lds
  s_mov_b32 m0, 67584
  s_mov_b32 s30, 608256
  buffer_load_dwordx4 v4, s[44:47], s30 offen lds
  s_mov_b32 m0, 68608
  s_mov_b32 s30, 617472
  buffer_load_dwordx4 v5, s[44:47], s30 offen lds
  s_mov_b32 m0, 69632
  s_mov_b32 s30, 626688
  buffer_load_dwordx4 v4, s[44:47], s30 offen lds
  s_mov_b32 m0, 70656
  s_mov_b32 s30, 635904
  buffer_load_dwordx4 v5, s[44:47], s30 offen lds
  s_mov_b32 m0, 71680
  s_mov_b32 s30, 645120
  buffer_load_dwordx4 v4, s[44:47], s30 offen lds
  s_mov_b32 m0, 72704
  s_mov_b32 s30, 654336
  buffer_load_dwordx4 v5, s[44:47], s30 offen lds
  s_barrier
  s_mov_b32 m0, 38912
  s_mov_b32 s30, 350208
  buffer_load_dwordx4 v4, s[44:47], s30 offen lds
  s_mov_b32 m0, 39936
  s_mov_b32 s30, 359424
  buffer_load_dwordx4 v5, s[44:47], s30 offen lds
  s_mov_b32 m0, 40960
  s_mov_b32 s30, 368640
  buffer_load_dwordx4 v4, s[44:47], s30 offen lds
  s_mov_b32 m0, 41984
  s_mov_b32 s30, 377856
  buffer_load_dwordx4 v5, s[44:47], s30 offen lds
  s_mov_b32 m0, 43008
  s_mov_b32 s30, 387072
  buffer_load_dwordx4 v4, s[44:47], s30 offen lds
  s_mov_b32 m0, 44032
  s_mov_b32 s30, 396288
  buffer_load_dwordx4 v5, s[44:47], s30 offen lds
  s_mov_b32 m0, 45056
  s_mov_b32 s30, 405504
  buffer_load_dwordx4 v4, s[44:47], s30 offen lds
  s_mov_b32 m0, 46080
  s_mov_b32 s30, 414720
  buffer_load_dwordx4 v5, s[44:47], s30 offen lds
  s_mov_b32 m0, 47104
  s_mov_b32 s30, 423936
  buffer_load_dwordx4 v4, s[44:47], s30 offen lds
  s_mov_b32 m0, 48128
  s_mov_b32 s30, 433152
  buffer_load_dwordx4 v5, s[44:47], s30 offen lds
  s_waitcnt vmcnt(0)
L_oproj:
  s_add_u32 s58, s40, s20
  s_mul_i32 s58, s58, 18432
  s_add_u32 s58, s58, 2621440
  v_lshlrev_b32 v102, 4, v2
  v_and_b32 v108, 15, v2
  v_lshrrev_b32 v109, 4, v2
  v_lshrrev_b32 v110, 2, v108
  v_lshl_add_u32 v111, v109, 3, v110
  v_lshlrev_b32 v104, 7, v111
  v_lshrrev_b32 v110, 1, v110
  v_and_b32 v111, 1, v109
  v_lshl_add_u32 v110, v111, 1, v110
  v_lshl_add_u32 v104, v110, 5, v104
  v_and_b32 v111, 3, v2
  v_lshl_add_u32 v104, v111, 3, v104
  v_xor_b32 v105, 32, v104
  v_xor_b32 v106, 64, v104
  v_xor_b32 v107, 96, v104
  s_barrier
  s_add_u32 s3, s40, s20
  s_lshl_b32 s3, s3, 7
  s_add_u32 s3, s3, 14201856
  v_lshlrev_b32 v100, 2, v2
  v_add_u32 v100, s3, v100
  s_mov_b64 exec, 0xffff
  s_mov_b32 s31, 0x10000
L_pl_16:
  global_load_dword v101, v100, s[12:13] sc1
  s_waitcnt vmcnt(0)
  v_cmp_eq_u32 vcc, 0, v101
  s_sub_u32 s31, s31, 1
  s_cbranch_scc1 L_pd_17
  s_nop 2
  s_cmp_eq_u64 vcc, 0
  s_cbranch_scc1 L_pd_17
  s_sleep 6
  s_branch L_pl_16
L_pd_17:
  s_mov_b64 exec, -1
  s_add_u32 s60, s58, 0
  buffer_load_dwordx4 v[4:7], v102, s[16:19], s60 offen sc1
  s_add_u32 s60, s58, 1024
  buffer_load_dwordx4 v[8:11], v102, s[16:19], s60 offen sc1
  s_add_u32 s60, s58, 2048
  buffer_load_dwordx4 v[12:15], v102, s[16:19], s60 offen sc1
  s_add_u32 s60, s58, 3072
  buffer_load_dwordx4 v[16:19], v102, s[16:19], s60 offen sc1
  s_add_u32 s60, s58, 4096
  buffer_load_dwordx4 v[20:23], v102, s[16:19], s60 offen sc1
  s_add_u32 s60, s58, 5120
  buffer_load_dwordx4 v[24:27], v102, s[16:19], s60 offen sc1
  s_add_u32 s60, s58, 6144
  buffer_load_dwordx4 v[28:31], v102, s[16:19], s60 offen sc1
  s_add_u32 s60, s58, 7168
  buffer_load_dwordx4 v[32:35], v102, s[16:19], s60 offen sc1
  s_add_u32 s60, s58, 8192
  buffer_load_dwordx4 v[36:39], v102, s[16:19], s60 offen sc1
  s_add_u32 s60, s58, 9216
  buffer_load_dwordx4 v[40:43], v102, s[16:19], s60 offen sc1
  s_add_u32 s60, s58, 10240
  buffer_load_dwordx4 v[44:47], v102, s[16:19], s60 offen sc1
  s_add_u32 s60, s58, 11264
  buffer_load_dwordx4 v[48:51], v102, s[16:19], s60 offen sc1
  ds_read_b64_tr_b16 v[52:53], v104 offset:0
  ds_read_b64_tr_b16 v[54:55], v104 offset:512
  ds_read_b64_tr_b16 v[56:57], v105 offset:0
  ds_read_b64_tr_b16 v[58:59], v105 offset:512
  ds_read_b64_tr_b16 v[60:61], v106 offset:0
  ds_read_b64_tr_b16 v[62:63], v106 offset:512
  ds_read_b64_tr_b16 v[64:65], v107 offset:0
  ds_read_b64_tr_b16 v[66:67], v107 offset:512
  ds_read_b64_tr_b16 v[68:69], v104 offset:4096
  ds_read_b64_tr_b16 v[70:71], v104 offset:4608
  ds_read_b64_tr_b16 v[72:73], v105 offset:4096
  ds_read_b64_tr_b16 v[74:75], v105 offset:4608
  ds_read_b64_tr_b16 v[76:77], v106 offset:4096
  ds_read_b64_tr_b16 v[78:79], v106 offset:4608
  ds_read_b64_tr_b16 v[80:81], v107 offset:4096
  ds_read_b64_tr_b16 v[82:83], v107 offset:4608
  s_waitcnt vmcnt(11) lgkmcnt(8)
  v_mfma_f32_16x16x32_bf16 v[84:87], v[52:55], v[4:7], 0
  v_mfma_f32_16x16x32_bf16 v[88:91], v[56:59], v[4:7], 0
  v_mfma_f32_16x16x32_bf16 v[92:95], v[60:63], v[4:7], 0
  v_mfma_f32_16x16x32_bf16 v[96:99], v[64:67], v[4:7], 0
  s_add_u32 s60, s58, 12288
  buffer_load_dwordx4 v[4:7], v102, s[16:19], s60 offen sc1
  ds_read_b64_tr_b16 v[52:53], v104 offset:8192
  ds_read_b64_tr_b16 v[54:55], v104 offset:8704
  ds_read_b64_tr_b16 v[56:57], v105 offset:8192
  ds_read_b64_tr_b16 v[58:59], v105 offset:8704
  ds_read_b64_tr_b16 v[60:61], v106 offset:8192
  ds_read_b64_tr_b16 v[62:63], v106 offset:8704
  ds_read_b64_tr_b16 v[64:65], v107 offset:8192
  ds_read_b64_tr_b16 v[66:67], v107 offset:8704
  s_waitcnt vmcnt(11) lgkmcnt(8)
  v_mfma_f32_16x16x32_bf16 v[84:87], v[68:71], v[8:11], v[84:87]
  v_mfma_f32_16x16x32_bf16 v[88:91], v[72:75], v[8:11], v[88:91]
  v_mfma_f32_16x16x32_bf16 v[92:95], v[76:79], v[8:11], v[92:95]
  v_mfma_f32_16x16x32_bf16 v[96:99], v[80:83], v[8:11], v[96:99]
  s_add_u32 s60, s58, 13312
  buffer_load_dwordx4 v[8:11], v102, s[16:19], s60 offen sc1
  ds_read_b64_tr_b16 v[68:69], v104 offset:12288
  ds_read_b64_tr_b16 v[70:71], v104 offset:12800
  ds_read_b64_tr_b16 v[72:73], v105 offset:12288
  ds_read_b64_tr_b16 v[74:75], v105 offset:12800
  ds_read_b64_tr_b16 v[76:77], v106 offset:12288
  ds_read_b64_tr_b16 v[78:79], v106 offset:12800
  ds_read_b64_tr_b16 v[80:81], v107 offset:12288
  ds_read_b64_tr_b16 v[82:83], v107 offset:12800
  s_waitcnt vmcnt(11) lgkmcnt(8)
  v_mfma_f32_16x16x32_bf16 v[84:87], v[52:55], v[12:15], v[84:87]
  v_mfma_f32_16x16x32_bf16 v[88:91], v[56:59], v[12:15], v[88:91]
  v_mfma_f32_16x16x32_bf16 v[92:95], v[60:63], v[12:15], v[92:95]
  v_mfma_f32_16x16x32_bf16 v[96:99], v[64:67], v[12:15], v[96:99]
  s_add_u32 s60, s58, 14336
  buffer_load_dwordx4 v[12:15], v102, s[16:19], s60 offen sc1
  ds_read_b64_tr_b16 v[52:53], v104 offset:16384
  ds_read_b64_tr_b16 v[54:55], v104 offset:16896
  ds_read_b64_tr_b16 v[56:57], v105 offset:16384
  ds_read_b64_tr_b16 v[58:59], v105 offset:16896
  ds_read_b64_tr_b16 v[60:61], v106 offset:16384
  ds_read_b64_tr_b16 v[62:63], v106 offset:16896
  ds_read_b64_tr_b16 v[64:65], v107 offset:16384
  ds_read_b64_tr_b16 v[66:67], v107 offset:16896
  s_waitcnt vmcnt(11) lgkmcnt(8)
  v_mfma_f32_16x16x32_bf16 v[84:87], v[68:71], v[16:19], v[84:87]
  v_mfma_f32_16x16x32_bf16 v[88:91], v[72:75], v[16:19], v[88:91]
  v_mfma_f32_16x16x32_bf16 v[92:95], v[76:79], v[16:19], v[92:95]
  v_mfma_f32_16x16x32_bf16 v[96:99], v[80:83], v[16:19], v[96:99]
  s_add_u32 s60, s58, 15360
  buffer_load_dwordx4 v[16:19], v102, s[16:19], s60 offen sc1
  ds_read_b64_tr_b16 v[68:69], v104 offset:20480
  ds_read_b64_tr_b16 v[70:71], v104 offset:20992
  ds_read_b64_tr_b16 v[72:73], v105 offset:20480
  ds_read_b64_tr_b16 v[74:75], v105 offset:20992
  ds_read_b64_tr_b16 v[76:77], v106 offset:20480
  ds_read_b64_tr_b16 v[78:79], v106 offset:20992
  ds_read_b64_tr_b16 v[80:81], v107 offset:20480
  ds_read_b64_tr_b16 v[82:83], v107 offset:20992
  s_waitcnt vmcnt(11) lgkmcnt(8)
  v_mfma_f32_16x16x32_bf16 v[84:87], v[52:55], v[20:23], v[84:87]
  v_mfma_f32_16x16x32_bf16 v[88:91], v[56:59], v[20:23], v[88:91]
  v_mfma_f32_16x16x32_bf16 v[92:95], v[60:63], v[20:23], v[92:95]
  v_mfma_f32_16x16x32_bf16 v[96:99], v[64:67], v[20:23], v[96:99]
  s_add_u32 s60, s58, 16384
  buffer_load_dwordx4 v[20:23], v102, s[16:19], s60 offen sc1
  ds_read_b64_tr_b16 v[52:53], v104 offset:24576
  ds_read_b64_tr_b16 v[54:55], v104 offset:25088
  ds_read_b64_tr_b16 v[56:57], v105 offset:24576
  ds_read_b64_tr_b16 v[58:59], v105 offset:25088
  ds_read_b64_tr_b16 v[60:61], v106 offset:24576
  ds_read_b64_tr_b16 v[62:63], v106 offset:25088
  ds_read_b64_tr_b16 v[64:65], v107 offset:24576
  ds_read_b64_tr_b16 v[66:67], v107 offset:25088
  s_waitcnt vmcnt(11) lgkmcnt(8)
  v_mfma_f32_16x16x32_bf16 v[84:87], v[68:71], v[24:27], v[84:87]
  v_mfma_f32_16x16x32_bf16 v[88:91], v[72:75], v[24:27], v[88:91]
  v_mfma_f32_16x16x32_bf16 v[92:95], v[76:79], v[24:27], v[92:95]
  v_mfma_f32_16x16x32_bf16 v[96:99], v[80:83], v[24:27], v[96:99]
  s_add_u32 s60, s58, 17408
  buffer_load_dwordx4 v[24:27], v102, s[16:19], s60 offen sc1
  ds_read_b64_tr_b16 v[68:69], v104 offset:28672
  ds_read_b64_tr_b16 v[70:71], v104 offset:29184
  ds_read_b64_tr_b16 v[72:73], v105 offset:28672
  ds_read_b64_tr_b16 v[74:75], v105 offset:29184
  ds_read_b64_tr_b16 v[76:77], v106 offset:28672
  ds_read_b64_tr_b16 v[78:79], v106 offset:29184
  ds_read_b64_tr_b16 v[80:81], v107 offset:28672
  ds_read_b64_tr_b16 v[82:83], v107 offset:29184
  s_waitcnt vmcnt(11) lgkmcnt(8)
  v_mfma_f32_16x16x32_bf16 v[84:87], v[52:55], v[28:31], v[84:87]
  v_mfma_f32_16x16x32_bf16 v[88:91], v[56:59], v[28:31], v[88:91]
  v_mfma_f32_16x16x32_bf16 v[92:95], v[60:63], v[28:31], v[92:95]
  v_mfma_f32_16x16x32_bf16 v[96:99], v[64:67], v[28:31], v[96:99]
  ds_read_b64_tr_b16 v[52:53], v104 offset:32768
  ds_read_b64_tr_b16 v[54:55], v104 offset:33280
  ds_read_b64_tr_b16 v[56:57], v105 offset:32768
  ds_read_b64_tr_b16 v[58:59], v105 offset:33280
  ds_read_b64_tr_b16 v[60:61], v106 offset:32768
  ds_read_b64_tr_b16 v[62:63], v106 offset:33280
  ds_read_b64_tr_b16 v[64:65], v107 offset:32768
  ds_read_b64_tr_b16 v[66:67], v107 offset:33280
  s_waitcnt vmcnt(10) lgkmcnt(8)
  v_mfma_f32_16x16x32_bf16 v[84:87], v[68:71], v[32:35], v[84:87]
  v_mfma_f32_16x16x32_bf16 v[88:91], v[72:75], v[32:35], v[88:91]
  v_mfma_f32_16x16x32_bf16 v[92:95], v[76:79], v[32:35], v[92:95]
  v_mfma_f32_16x16x32_bf16 v[96:99], v[80:83], v[32:35], v[96:99]
  v_add_u32 v104, 36864, v104
  v_add_u32 v105, 36864, v105
  v_add_u32 v106, 36864, v106
  v_add_u32 v107, 36864, v107
  ds_read_b64_tr_b16 v[68:69], v104 offset:0
  ds_read_b64_tr_b16 v[70:71], v104 offset:512
  ds_read_b64_tr_b16 v[72:73], v105 offset:0
  ds_read_b64_tr_b16 v[74:75], v105 offset:512
  ds_read_b64_tr_b16 v[76:77], v106 offset:0
  ds_read_b64_tr_b16 v[78:79], v106 offset:512
  ds_read_b64_tr_b16 v[80:81], v107 offset:0
  ds_read_b64_tr_b16 v[82:83], v107 offset:512
  s_waitcnt vmcnt(9) lgkmcnt(8)
  v_mfma_f32_16x16x32_bf16 v[84:87], v[52:55], v[36:39], v[84:87]
  v_mfma_f32_16x16x32_bf16 v[88:91], v[56:59], v[36:39], v[88:91]
  v_mfma_f32_16x16x32_bf16 v[92:95], v[60:63], v[36:39], v[92:95]
  v_mfma_f32_16x16x32_bf16 v[96:99], v[64:67], v[36:39], v[96:99]
  ds_read_b64_tr_b16 v[52:53], v104 offset:4096
  ds_read_b64_tr_b16 v[54:55], v104 offset:4608
  ds_read_b64_tr_b16 v[56:57], v105 offset:4096
  ds_read_b64_tr_b16 v[58:59], v105 offset:4608
  ds_read_b64_tr_b16 v[60:61], v106 offset:4096
  ds_read_b64_tr_b16 v[62:63], v106 offset:4608
  ds_read_b64_tr_b16 v[64:65], v107 offset:4096
  ds_read_b64_tr_b16 v[66:67], v107 offset:4608
  s_waitcnt vmcnt(8) lgkmcnt(8)
  v_mfma_f32_16x16x32_bf16 v[84:87], v[68:71], v[40:43], v[84:87]
  v_mfma_f32_16x16x32_bf16 v[88:91], v[72:75], v[40:43], v[88:91]
  v_mfma_f32_16x16x32_bf16 v[92:95], v[76:79], v[40:43], v[92:95]
  v_mfma_f32_16x16x32_bf16 v[96:99], v[80:83], v[40:43], v[96:99]
  s_barrier
  ds_read_b64_tr_b16 v[68:69], v104 offset:8192
  ds_read_b64_tr_b16 v[70:71], v104 offset:8704
  ds_read_b64_tr_b16 v[72:73], v105 offset:8192
  ds_read_b64_tr_b16 v[74:75], v105 offset:8704
  ds_read_b64_tr_b16 v[76:77], v106 offset:8192
  ds_read_b64_tr_b16 v[78:79], v106 offset:8704
  ds_read_b64_tr_b16 v[80:81], v107 offset:8192
  ds_read_b64_tr_b16 v[82:83], v107 offset:8704
  s_waitcnt vmcnt(7) lgkmcnt(8)
  v_mfma_f32_16x16x32_bf16 v[84:87], v[52:55], v[44:47], v[84:87]
  v_mfma_f32_16x16x32_bf16 v[88:91], v[56:59], v[44:47], v[88:91]
  v_mfma_f32_16x16x32_bf16 v[92:95], v[60:63], v[44:47], v[92:95]
  v_mfma_f32_16x16x32_bf16 v[96:99], v[64:67], v[44:47], v[96:99]
  ds_read_b64_tr_b16 v[52:53], v104 offset:12288
  ds_read_b64_tr_b16 v[54:55], v104 offset:12800
  ds_read_b64_tr_b16 v[56:57], v105 offset:12288
  ds_read_b64_tr_b16 v[58:59], v105 offset:12800
  ds_read_b64_tr_b16 v[60:61], v106 offset:12288
  ds_read_b64_tr_b16 v[62:63], v106 offset:12800
  ds_read_b64_tr_b16 v[64:65], v107 offset:12288
  ds_read_b64_tr_b16 v[66:67], v107 offset:12800
  s_waitcnt vmcnt(6) lgkmcnt(8)
  v_mfma_f32_16x16x32_bf16 v[84:87], v[68:71], v[48:51], v[84:87]
  v_mfma_f32_16x16x32_bf16 v[88:91], v[72:75], v[48:51], v[88:91]
  v_mfma_f32_16x16x32_bf16 v[92:95], v[76:79], v[48:51], v[92:95]
  v_mfma_f32_16x16x32_bf16 v[96:99], v[80:83], v[48:51], v[96:99]
  ds_read_b64_tr_b16 v[68:69], v104 offset:16384
  ds_read_b64_tr_b16 v[70:71], v104 offset:16896
  ds_read_b64_tr_b16 v[72:73], v105 offset:16384
  ds_read_b64_tr_b16 v[74:75], v105 offset:16896
  ds_read_b64_tr_b16 v[76:77], v106 offset:16384
  ds_read_b64_tr_b16 v[78:79], v106 offset:16896
  ds_read_b64_tr_b16 v[80:81], v107 offset:16384
  ds_read_b64_tr_b16 v[82:83], v107 offset:16896
  s_waitcnt vmcnt(5) lgkmcnt(8)
  v_mfma_f32_16x16x32_bf16 v[84:87], v[52:55], v[4:7], v[84:87]
  v_mfma_f32_16x16x32_bf16 v[88:91], v[56:59], v[4:7], v[88:91]
  v_mfma_f32_16x16x32_bf16 v[92:95], v[60:63], v[4:7], v[92:95]
  v_mfma_f32_16x16x32_bf16 v[96:99], v[64:67], v[4:7], v[96:99]
  ds_read_b64_tr_b16 v[52:53], v104 offset:20480
  ds_read_b64_tr_b16 v[54:55], v104 offset:20992
  ds_read_b64_tr_b16 v[56:57], v105 offset:20480
  ds_read_b64_tr_b16 v[58:59], v105 offset:20992
  ds_read_b64_tr_b16 v[60:61], v106 offset:20480
  ds_read_b64_tr_b16 v[62:63], v106 offset:20992
  ds_read_b64_tr_b16 v[64:65], v107 offset:20480
  ds_read_b64_tr_b16 v[66:67], v107 offset:20992
  s_waitcnt vmcnt(4) lgkmcnt(8)
  v_mfma_f32_16x16x32_bf16 v[84:87], v[68:71], v[8:11], v[84:87]
  v_mfma_f32_16x16x32_bf16 v[88:91], v[72:75], v[8:11], v[88:91]
  v_mfma_f32_16x16x32_bf16 v[92:95], v[76:79], v[8:11], v[92:95]
  v_mfma_f32_16x16x32_bf16 v[96:99], v[80:83], v[8:11], v[96:99]
  ds_read_b64_tr_b16 v[68:69], v104 offset:24576
  ds_read_b64_tr_b16 v[70:71], v104 offset:25088
  ds_read_b64_tr_b16 v[72:73], v105 offset:24576
  ds_read_b64_tr_b16 v[74:75], v105 offset:25088
  ds_read_b64_tr_b16 v[76:77], v106 offset:24576
  ds_read_b64_tr_b16 v[78:79], v106 offset:25088
  ds_read_b64_tr_b16 v[80:81], v107 offset:24576
  ds_read_b64_tr_b16 v[82:83], v107 offset:25088
  s_waitcnt vmcnt(3) lgkmcnt(8)
  v_mfma_f32_16x16x32_bf16 v[84:87], v[52:55], v[12:15], v[84:87]
  v_mfma_f32_16x16x32_bf16 v[88:91], v[56:59], v[12:15], v[88:91]
  v_mfma_f32_16x16x32_bf16 v[92:95], v[60:63], v[12:15], v[92:95]
  v_mfma_f32_16x16x32_bf16 v[96:99], v[64:67], v[12:15], v[96:99]
  ds_read_b64_tr_b16 v[52:53], v104 offset:28672
  ds_read_b64_tr_b16 v[54:55], v104 offset:29184
  ds_read_b64_tr_b16 v[56:57], v105 offset:28672
  ds_read_b64_tr_b16 v[58:59], v105 offset:29184
  ds_read_b64_tr_b16 v[60:61], v106 offset:28672
  ds_read_b64_tr_b16 v[62:63], v106 offset:29184
  ds_read_b64_tr_b16 v[64:65], v107 offset:28672
  ds_read_b64_tr_b16 v[66:67], v107 offset:29184
  s_waitcnt vmcnt(2) lgkmcnt(8)
  v_mfma_f32_16x16x32_bf16 v[84:87], v[68:71], v[16:19], v[84:87]
  v_mfma_f32_16x16x32_bf16 v[88:91], v[72:75], v[16:19], v[88:91]
  v_mfma_f32_16x16x32_bf16 v[92:95], v[76:79], v[16:19], v[92:95]
  v_mfma_f32_16x16x32_bf16 v[96:99], v[80:83], v[16:19], v[96:99]
  ds_read_b64_tr_b16 v[68:69], v104 offset:32768
  ds_read_b64_tr_b16 v[70:71], v104 offset:33280
  ds_read_b64_tr_b16 v[72:73], v105 offset:32768
  ds_read_b64_tr_b16 v[74:75], v105 offset:33280
  ds_read_b64_tr_b16 v[76:77], v106 offset:32768
  ds_read_b64_tr_b16 v[78:79], v106 offset:33280
  ds_read_b64_tr_b16 v[80:81], v107 offset:32768
  ds_read_b64_tr_b16 v[82:83], v107 offset:33280
  s_waitcnt vmcnt(1) lgkmcnt(8)
  v_mfma_f32_16x16x32_bf16 v[84:87], v[52:55], v[20:23], v[84:87]
  v_mfma_f32_16x16x32_bf16 v[88:91], v[56:59], v[20:23], v[88:91]
  v_mfma_f32_16x16x32_bf16 v[92:95], v[60:63], v[20:23], v[92:95]
  v_mfma_f32_16x16x32_bf16 v[96:99], v[64:67], v[20:23], v[96:99]
  s_waitcnt vmcnt(0) lgkmcnt(0)
  v_mfma_f32_16x16x32_bf16 v[84:87], v[68:71], v[24:27], v[84:87]
  v_mfma_f32_16x16x32_bf16 v[88:91], v[72:75], v[24:27], v[88:91]
  v_mfma_f32_16x16x32_bf16 v[92:95], v[76:79], v[24:27], v[92:95]
  v_mfma_f32_16x16x32_bf16 v[96:99], v[80:83], v[24:27], v[96:99]
  s_mul_i32 s59, s20, 2304
  v_mul_u32_u24 v100, 144, v108
  v_lshl_add_u32 v100, v109, 3, v100
  v_add_u32 v100, s59, v100
  v_lshrrev_b32 v110, 3, v2
  v_and_b32 v111, 7, v2
  v_mul_u32_u24 v101, 144, v110
  v_lshl_add_u32 v101, v111, 4, v101
  v_add_u32 v101, s59, v101
  v_mul_u32_u24 v102, 2304, v110
  v_lshl_add_u32 v102, v111, 4, v102
  s_add_u32 s58, s40, s20
  s_mul_i32 s58, s58, 36864
  s_add_u32 s58, s58, s41
  s_add_u32 s58, s58, 1152
  s_add_u32 s59, s58, 18432
  v_cvt_pk_bf16_f32 v4, v84, v85
  v_cvt_pk_bf16_f32 v5, v86, v87
  ds_write_b64 v100, v[4:5] offset:0
  v_cvt_pk_bf16_f32 v6, v88, v89
  v_cvt_pk_bf16_f32 v7, v90, v91
  ds_write_b64 v100, v[6:7] offset:32
  v_cvt_pk_bf16_f32 v8, v92, v93
  v_cvt_pk_bf16_f32 v9, v94, v95
  ds_write_b64 v100, v[8:9] offset:64
  v_cvt_pk_bf16_f32 v10, v96, v97
  v_cvt_pk_bf16_f32 v11, v98, v99
  ds_write_b64 v100, v[10:11] offset:96
  s_waitcnt lgkmcnt(0)
  ds_read_b128 v[12:15], v101
  ds_read_b128 v[16:19], v101 offset:1152
  s_waitcnt lgkmcnt(1)
  buffer_store_dwordx4 v[12:15], v102, s[48:51], s58 offen sc1
  s_waitcnt lgkmcnt(0)
  buffer_store_dwordx4 v[16:19], v102, s[48:51], s59 offen sc1
  s_endpgm
L_ld_notask:
  s_waitcnt vmcnt(19)
  s_barrier
  v_mov_b32 v20, 132
  global_load_dword v21, v20, s[14:15]
  s_waitcnt vmcnt(0)
  v_readfirstlane_b32 s31, v21
  s_nop 3
  s_cmp_lg_u32 s31, 0
  s_cbranch_scc1 L_rdy_18
  s_sleep 12
  s_mov_b32 s31, 0x10000
L_pl_19:
  global_load_dword v21, v20, s[14:15] sc1
  s_waitcnt vmcnt(0)
  v_cmp_eq_u32 vcc, 0, v21
  s_sub_u32 s31, s31, 1
  s_cbranch_scc1 L_pd_20
  s_nop 2
  s_cmp_eq_u64 vcc, 0
  s_cbranch_scc1 L_pd_20
  s_sleep 12
  s_branch L_pl_19
L_pd_20:
L_rdy_18:
  s_waitcnt vmcnt(0)
  s_barrier
  s_waitcnt vmcnt(0)
  s_barrier
  s_endpgm
L_conv:
  s_and_b32 s21, s2, 7
  s_mul_i32 s21, s21, 72
  s_sub_u32 s22, s2, 256
  s_lshr_b32 s22, s22, 3
  s_waitcnt lgkmcnt(0)
  s_mov_b32 s16, s12
  s_and_b32 s17, s13, 0xffff
  s_mov_b32 s18, 16777216
  s_mov_b32 s19, 0x00020000
  s_mov_b32 s8, s60
  s_and_b32 s9, s61, 0xffff
  s_mov_b32 s10, 2359296
  s_mov_b32 s11, 0x00020000
  s_mov_b32 s4, s62
  s_and_b32 s5, s63, 0xffff
  s_mov_b32 s6, 4718592
  s_mov_b32 s7, 0x00020000
  s_cmp_ge_u32 s2, 384
  s_cbranch_scc1 L_nkv_23
  s_setprio 3
  s_cmp_eq_u32 s20, 4
  s_cbranch_scc1 L_kvl_24
  s_and_b32 s33, s2, 7
  s_lshl_b32 s33, s33, 3
  s_and_b32 s3, s22, 7
  s_add_u32 s33, s33, s3
  s_lshr_b32 s34, s22, 3
  s_cmp_eq_u32 s34, 0
  s_cselect_b32 s24, s92, s94
  s_cselect_b32 s25, s93, s95
  s_mov_b32 s44, s88
  s_and_b32 s45, s89, 0xffff
  s_mov_b32 s46, 2359296
  s_mov_b32 s47, 0x00020000
  s_mov_b32 s48, s24
  s_and_b32 s49, s25, 0xffff
  s_mov_b32 s50, 20736
  s_mov_b32 s51, 0x00020000
  v_lshrrev_b32 v4, 3, v2
  v_and_b32 v5, 7, v2
  s_lshl_b32 s3, s33, 5
  s_lshl_b32 s26, s20, 3
  s_add_u32 s3, s3, s26
  v_add_u32 v6, s3, v4
  v_mul_u32_u24 v12, 1152, v6
  s_lshl_b32 s26, s20, 2
  v_lshrrev_b32 v6, 1, v4
  v_add_u32 v6, s26, v6
  v_and_b32 v6, 7, v6
  v_xor_b32 v6, v6, v5
  v_lshl_add_u32 v12, v6, 4, v12
  s_lshl_b32 s27, s20, 10
  s_and_b32 s28, s20, 1
  s_lshr_b32 s29, s20, 1
  v_lshlrev_b32 v13, 4, v2
  s_lshl_b32 s3, s28, 2
  s_lshl_b32 s26, s29, 10
  s_add_u32 s3, s3, s26
  v_add_u32 v13, s3, v13
  s_mul_i32 s3, s28, 21504
  s_add_u32 s26, s26, s3
  s_add_u32 s26, s26, 36864
  s_add_u32 m0, s26, 0
  s_mov_b32 s3, 0
  buffer_load_dwordx4 v13, s[48:51], s3 offen lds
  s_add_u32 m0, s26, 2048
  s_mov_b32 s3, 2048
  buffer_load_dwordx4 v13, s[48:51], s3 offen lds
  s_add_u32 m0, s26, 4096
  s_mov_b32 s3, 4096
  buffer_load_dwordx4 v13, s[48:51], s3 offen lds
  s_add_u32 m0, s26, 6144
  s_mov_b32 s3, 6144
  buffer_load_dwordx4 v13, s[48:51], s3 offen lds
  s_add_u32 m0, s27, 0
  s_mov_b32 s3, 0
  buffer_load_dwordx4 v12, s[44:47], s3 offen lds
  s_add_u32 m0, s27, 4096
  s_mov_b32 s3, 128
  buffer_load_dwordx4 v12, s[44:47], s3 offen lds
  s_add_u32 m0, s27, 8192
  s_mov_b32 s3, 256
  buffer_load_dwordx4 v12, s[44:47], s3 offen lds
  s_add_u32 m0, s26, 8192
  s_mov_b32 s3, 8192
  buffer_load_dwordx4 v13, s[48:51], s3 offen lds
  s_add_u32 m0, s26, 10240
  s_mov_b32 s3, 10240
  buffer_load_dwordx4 v13, s[48:51], s3 offen lds
  s_add_u32 m0, s26, 12288
  s_mov_b32 s3, 12288
  buffer_load_dwordx4 v13, s[48:51], s3 offen lds
  s_add_u32 m0, s27, 12288
  s_mov_b32 s3, 384
  buffer_load_dwordx4 v12, s[44:47], s3 offen lds
  s_add_u32 m0, s27, 16384
  s_mov_b32 s3, 512
  buffer_load_dwordx4 v12, s[44:47], s3 offen lds
  s_add_u32 m0, s27, 20480
  s_mov_b32 s3, 640
  buffer_load_dwordx4 v12, s[44:47], s3 offen lds
  s_add_u32 m0, s26, 14336
  s_mov_b32 s3, 14336
  buffer_load_dwordx4 v13, s[48:51], s3 offen lds
  s_add_u32 m0, s26, 16384
  s_mov_b32 s3, 16384
  buffer_load_dwordx4 v13, s[48:51], s3 offen lds
  s_add_u32 m0, s26, 18432
  s_mov_b32 s3, 18432
  buffer_load_dwordx4 v13, s[48:51], s3 offen lds
  s_cmp_lg_u32 s29, 0
  s_cbranch_scc1 L_kws_25
  s_add_u32 m0, s26, 20480
  s_mov_b32 s3, 20480
  buffer_load_dwordx4 v13, s[48:51], s3 offen lds
L_kws_25:
  s_add_u32 m0, s27, 24576
  s_mov_b32 s3, 768
  buffer_load_dwordx4 v12, s[44:47], s3 offen lds
  s_add_u32 m0, s27, 28672
  s_mov_b32 s3, 896
  buffer_load_dwordx4 v12, s[44:47], s3 offen lds
  s_add_u32 m0, s27, 32768
  s_mov_b32 s3, 1024
  buffer_load_dwordx4 v12, s[44:47], s3 offen lds
  v_and_b32 v14, 15, v2
  v_lshrrev_b32 v15, 4, v2
  v_lshrrev_b32 v9, 1, v14
  v_xor_b32 v9, v9, v15
  v_lshlrev_b32 v9, 4, v9
  v_lshl_add_u32 v16, v14, 7, v9
  s_lshl_b32 s3, s29, 11
  v_add_u32 v16, s3, v16
  v_xor_b32 v17, 64, v16
  v_lshrrev_b32 v5, 2, v14
  v_lshl_add_u32 v6, v15, 3, v5
  v_mul_u32_u24 v18, 36, v6
  v_and_b32 v5, 1, v5
  v_mul_u32_u24 v5, 21500, v5
  v_add_u32 v18, v18, v5
  v_and_b32 v6, 3, v2
  v_lshl_add_u32 v18, v6, 3, v18
  s_lshl_b32 s3, s28, 5
  s_add_u32 s3, s3, 36864
  v_add_u32 v18, s3, v18
  s_cmp_lg_u32 s34, 0
  s_cbranch_scc1 L_kvv_26
  s_waitcnt vmcnt(12)
  s_barrier
  ds_read_b128 v[20:23], v16 offset:0
  ds_read_b64_tr_b16 v[44:45], v18 offset:0
  ds_read_b64_tr_b16 v[46:47], v18 offset:144
  ds_read_b128 v[24:27], v17 offset:0
  ds_read_b64_tr_b16 v[48:49], v18 offset:1152
  ds_read_b64_tr_b16 v[50:51], v18 offset:1296
  ds_read_b128 v[28:31], v16 offset:4096
  ds_read_b64_tr_b16 v[52:53], v18 offset:2304
  ds_read_b64_tr_b16 v[54:55], v18 offset:2448
  s_waitcnt lgkmcnt(6)
  ds_read_b128 v[32:35], v17 offset:4096
  ds_read_b64_tr_b16 v[56:57], v18 offset:3456
  ds_read_b64_tr_b16 v[58:59], v18 offset:3600
  ds_read_b128 v[36:39], v16 offset:8192
  ds_read_b64_tr_b16 v[60:61], v18 offset:4608
  ds_read_b64_tr_b16 v[62:63], v18 offset:4752
  ds_read_b128 v[40:43], v17 offset:8192
  ds_read_b64_tr_b16 v[64:65], v18 offset:5760
  ds_read_b64_tr_b16 v[66:67], v18 offset:5904
  s_waitcnt lgkmcnt(9)
  v_mfma_f32_16x16x32_bf16 v[68:71], v[44:47], v[20:23], 0
  v_mfma_f32_16x16x32_bf16 v[68:71], v[48:51], v[24:27], v[68:71]
  v_mfma_f32_16x16x32_bf16 v[68:71], v[52:55], v[28:31], v[68:71]
  s_waitcnt lgkmcnt(0)
  v_mfma_f32_16x16x32_bf16 v[68:71], v[56:59], v[32:35], v[68:71]
  v_mfma_f32_16x16x32_bf16 v[68:71], v[60:63], v[36:39], v[68:71]
  v_mfma_f32_16x16x32_bf16 v[68:71], v[64:67], v[40:43], v[68:71]
  s_waitcnt vmcnt(6)
  s_barrier
  ds_read_b128 v[20:23], v16 offset:12288
  ds_read_b64_tr_b16 v[44:45], v18 offset:6912
  ds_read_b64_tr_b16 v[46:47], v18 offset:7056
  ds_read_b128 v[24:27], v17 offset:12288
  ds_read_b64_tr_b16 v[48:49], v18 offset:8064
  ds_read_b64_tr_b16 v[50:51], v18 offset:8208
  ds_read_b128 v[28:31], v16 offset:16384
  ds_read_b64_tr_b16 v[52:53], v18 offset:9216
  ds_read_b64_tr_b16 v[54:55], v18 offset:9360
  s_waitcnt lgkmcnt(6)
  ds_read_b128 v[32:35], v17 offset:16384
  ds_read_b64_tr_b16 v[56:57], v18 offset:10368
  ds_read_b64_tr_b16 v[58:59], v18 offset:10512
  ds_read_b128 v[36:39], v16 offset:20480
  ds_read_b64_tr_b16 v[60:61], v18 offset:11520
  ds_read_b64_tr_b16 v[62:63], v18 offset:11664
  ds_read_b128 v[40:43], v17 offset:20480
  ds_read_b64_tr_b16 v[64:65], v18 offset:12672
  ds_read_b64_tr_b16 v[66:67], v18 offset:12816
  s_waitcnt lgkmcnt(9)
  v_mfma_f32_16x16x32_bf16 v[68:71], v[44:47], v[20:23], v[68:71]
  v_mfma_f32_16x16x32_bf16 v[68:71], v[48:51], v[24:27], v[68:71]
  v_mfma_f32_16x16x32_bf16 v[68:71], v[52:55], v[28:31], v[68:71]
  s_waitcnt lgkmcnt(0)
  v_mfma_f32_16x16x32_bf16 v[68:71], v[56:59], v[32:35], v[68:71]
  v_mfma_f32_16x16x32_bf16 v[68:71], v[60:63], v[36:39], v[68:71]
  v_mfma_f32_16x16x32_bf16 v[68:71], v[64:67], v[40:43], v[68:71]
  s_waitcnt vmcnt(0)
  s_barrier
  ds_read_b128 v[20:23], v16 offset:24576
  ds_read_b64_tr_b16 v[44:45], v18 offset:13824
  ds_read_b64_tr_b16 v[46:47], v18 offset:13968
  ds_read_b128 v[24:27], v17 offset:24576
  ds_read_b64_tr_b16 v[48:49], v18 offset:14976
  ds_read_b64_tr_b16 v[50:51], v18 offset:15120
  ds_read_b128 v[28:31], v16 offset:28672
  ds_read_b64_tr_b16 v[52:53], v18 offset:16128
  ds_read_b64_tr_b16 v[54:55], v18 offset:16272
  s_waitcnt lgkmcnt(6)
  ds_read_b128 v[32:35], v17 offset:28672
  ds_read_b64_tr_b16 v[56:57], v18 offset:17280
  ds_read_b64_tr_b16 v[58:59], v18 offset:17424
  ds_read_b128 v[36:39], v16 offset:32768
  ds_read_b64_tr_b16 v[60:61], v18 offset:18432
  ds_read_b64_tr_b16 v[62:63], v18 offset:18576
  ds_read_b128 v[40:43], v17 offset:32768
  ds_read_b64_tr_b16 v[64:65], v18 offset:19584
  ds_read_b64_tr_b16 v[66:67], v18 offset:19728
  s_waitcnt lgkmcnt(9)
  v_mfma_f32_16x16x32_bf16 v[68:71], v[44:47], v[20:23], v[68:71]
  v_mfma_f32_16x16x32_bf16 v[68:71], v[48:51], v[24:27], v[68:71]
  v_mfma_f32_16x16x32_bf16 v[68:71], v[52:55], v[28:31], v[68:71]
  s_waitcnt lgkmcnt(0)
  v_mfma_f32_16x16x32_bf16 v[68:71], v[56:59], v[32:35], v[68:71]
  v_mfma_f32_16x16x32_bf16 v[68:71], v[60:63], v[36:39], v[68:71]
  v_mfma_f32_16x16x32_bf16 v[68:71], v[64:67], v[40:43], v[68:71]
  s_nop 7
  v_cvt_pk_bf16_f32 v20, v68, v69
  v_cvt_pk_bf16_f32 v21, v70, v71
  v_mov_b32 v11, 0
  s_cmp_eq_u32 s28, 1
  s_cbranch_scc1 L_kvk1_27
  v_lshrrev_b32 v5, 1, v15
  v_lshlrev_b32 v5, 9, v5
  v_and_b32 v6, 1, v15
  v_lshl_add_u32 v5, v6, 3, v5
  v_lshl_add_u32 v5, v14, 4, v5
  s_lshl_b32 s3, s29, 8
  s_add_u32 s3, s3, 79872
  v_add_u32 v5, s3, v5
  ds_write_b64 v5, v[20:21]
  v_dot2c_f32_bf16 v11, v20, v20
  v_dot2c_f32_bf16 v11, v21, v21
  s_nop 3
  v_mov_b32 v9, v11
  s_nop 1
  v_permlane32_swap_b32 v11, v9
  s_nop 1
  v_add_f32 v11, v11, v9
  v_mov_b32 v9, v11
  s_nop 1
  v_permlane16_swap_b32 v11, v9
  s_nop 1
  v_add_f32 v11, v11, v9
  s_branch L_kvnm_29
L_kvk1_27:
  v_lshlrev_b32 v5, 2, v14
  s_lshl_b32 s3, s29, 6
  s_add_u32 s3, s3, 80896
  v_add_u32 v5, s3, v5
  s_mov_b64 exec, 0xffff
  ds_write_b32 v5, v20
  v_dot2c_f32_bf16 v11, v20, v20
  s_mov_b64 exec, -1
  s_nop 4
L_kvnm_29:
  s_nop 1
  v_max_f32_dpp v11, v11, v11 row_ror:8 row_mask:0xf bank_mask:0xf
  s_nop 1
  v_max_f32_dpp v11, v11, v11 row_ror:4 row_mask:0xf bank_mask:0xf
  s_nop 1
  v_max_f32_dpp v11, v11, v11 row_ror:2 row_mask:0xf bank_mask:0xf
  s_nop 1
  v_max_f32_dpp v11, v11, v11 row_ror:1 row_mask:0xf bank_mask:0xf
  s_lshl_b32 s3, s20, 2
  s_add_u32 s3, s3, 81024
  v_mov_b32 v4, s3
  s_mov_b64 exec, 1
  ds_write_b32 v4, v11
  s_mov_b64 exec, -1
  s_branch L_kvst_28
L_kvv_26:
  s_waitcnt vmcnt(12)
  s_barrier
  ds_read_b128 v[20:23], v16 offset:0
  ds_read_b64_tr_b16 v[44:45], v18 offset:0
  ds_read_b64_tr_b16 v[46:47], v18 offset:144
  ds_read_b128 v[24:27], v17 offset:0
  ds_read_b64_tr_b16 v[48:49], v18 offset:1152
  ds_read_b64_tr_b16 v[50:51], v18 offset:1296
  ds_read_b128 v[28:31], v16 offset:4096
  ds_read_b64_tr_b16 v[52:53], v18 offset:2304
  ds_read_b64_tr_b16 v[54:55], v18 offset:2448
  s_waitcnt lgkmcnt(6)
  ds_read_b128 v[32:35], v17 offset:4096
  ds_read_b64_tr_b16 v[56:57], v18 offset:3456
  ds_read_b64_tr_b16 v[58:59], v18 offset:3600
  ds_read_b128 v[36:39], v16 offset:8192
  ds_read_b64_tr_b16 v[60:61], v18 offset:4608
  ds_read_b64_tr_b16 v[62:63], v18 offset:4752
  ds_read_b128 v[40:43], v17 offset:8192
  ds_read_b64_tr_b16 v[64:65], v18 offset:5760
  ds_read_b64_tr_b16 v[66:67], v18 offset:5904
  s_waitcnt lgkmcnt(9)
  v_mfma_f32_16x16x32_bf16 v[68:71], v[20:23], v[44:47], 0
  v_mfma_f32_16x16x32_bf16 v[68:71], v[24:27], v[48:51], v[68:71]
  v_mfma_f32_16x16x32_bf16 v[68:71], v[28:31], v[52:55], v[68:71]
  s_waitcnt lgkmcnt(0)
  v_mfma_f32_16x16x32_bf16 v[68:71], v[32:35], v[56:59], v[68:71]
  v_mfma_f32_16x16x32_bf16 v[68:71], v[36:39], v[60:63], v[68:71]
  v_mfma_f32_16x16x32_bf16 v[68:71], v[40:43], v[64:67], v[68:71]
  s_waitcnt vmcnt(6)
  s_barrier
  ds_read_b128 v[20:23], v16 offset:12288
  ds_read_b64_tr_b16 v[44:45], v18 offset:6912
  ds_read_b64_tr_b16 v[46:47], v18 offset:7056
  ds_read_b128 v[24:27], v17 offset:12288
  ds_read_b64_tr_b16 v[48:49], v18 offset:8064
  ds_read_b64_tr_b16 v[50:51], v18 offset:8208
  ds_read_b128 v[28:31], v16 offset:16384
  ds_read_b64_tr_b16 v[52:53], v18 offset:9216
  ds_read_b64_tr_b16 v[54:55], v18 offset:9360
  s_waitcnt lgkmcnt(6)
  ds_read_b128 v[32:35], v17 offset:16384
  ds_read_b64_tr_b16 v[56:57], v18 offset:10368
  ds_read_b64_tr_b16 v[58:59], v18 offset:10512
  ds_read_b128 v[36:39], v16 offset:20480
  ds_read_b64_tr_b16 v[60:61], v18 offset:11520
  ds_read_b64_tr_b16 v[62:63], v18 offset:11664
  ds_read_b128 v[40:43], v17 offset:20480
  ds_read_b64_tr_b16 v[64:65], v18 offset:12672
  ds_read_b64_tr_b16 v[66:67], v18 offset:12816
  s_waitcnt lgkmcnt(9)
  v_mfma_f32_16x16x32_bf16 v[68:71], v[20:23], v[44:47], v[68:71]
  v_mfma_f32_16x16x32_bf16 v[68:71], v[24:27], v[48:51], v[68:71]
  v_mfma_f32_16x16x32_bf16 v[68:71], v[28:31], v[52:55], v[68:71]
  s_waitcnt lgkmcnt(0)
  v_mfma_f32_16x16x32_bf16 v[68:71], v[32:35], v[56:59], v[68:71]
  v_mfma_f32_16x16x32_bf16 v[68:71], v[36:39], v[60:63], v[68:71]
  v_mfma_f32_16x16x32_bf16 v[68:71], v[40:43], v[64:67], v[68:71]
  s_waitcnt vmcnt(0)
  s_barrier
  ds_read_b128 v[20:23], v16 offset:24576
  ds_read_b64_tr_b16 v[44:45], v18 offset:13824
  ds_read_b64_tr_b16 v[46:47], v18 offset:13968
  ds_read_b128 v[24:27], v17 offset:24576
  ds_read_b64_tr_b16 v[48:49], v18 offset:14976
  ds_read_b64_tr_b16 v[50:51], v18 offset:15120
  ds_read_b128 v[28:31], v16 offset:28672
  ds_read_b64_tr_b16 v[52:53], v18 offset:16128
  ds_read_b64_tr_b16 v[54:55], v18 offset:16272
  s_waitcnt lgkmcnt(6)
  ds_read_b128 v[32:35], v17 offset:28672
  ds_read_b64_tr_b16 v[56:57], v18 offset:17280
  ds_read_b64_tr_b16 v[58:59], v18 offset:17424
  ds_read_b128 v[36:39], v16 offset:32768
  ds_read_b64_tr_b16 v[60:61], v18 offset:18432
  ds_read_b64_tr_b16 v[62:63], v18 offset:18576
  ds_read_b128 v[40:43], v17 offset:32768
  ds_read_b64_tr_b16 v[64:65], v18 offset:19584
  ds_read_b64_tr_b16 v[66:67], v18 offset:19728
  s_waitcnt lgkmcnt(9)
  v_mfma_f32_16x16x32_bf16 v[68:71], v[20:23], v[44:47], v[68:71]
  v_mfma_f32_16x16x32_bf16 v[68:71], v[24:27], v[48:51], v[68:71]
  v_mfma_f32_16x16x32_bf16 v[68:71], v[28:31], v[52:55], v[68:71]
  s_waitcnt lgkmcnt(0)
  v_mfma_f32_16x16x32_bf16 v[68:71], v[32:35], v[56:59], v[68:71]
  v_mfma_f32_16x16x32_bf16 v[68:71], v[36:39], v[60:63], v[68:71]
  v_mfma_f32_16x16x32_bf16 v[68:71], v[40:43], v[64:67], v[68:71]
  s_nop 7
  v_cvt_pk_bf16_f32 v20, v68, v69
  v_cvt_pk_bf16_f32 v21, v70, v71
  s_lshl_b32 s3, s28, 4
  v_add_u32 v4, s3, v14
  v_lshrrev_b32 v5, 1, v15
  v_mul_u32_u24 v5, 20, v5
  v_add_u32 v5, v5, v4
  v_lshlrev_b32 v5, 4, v5
  v_and_b32 v6, 1, v15
  v_lshl_add_u32 v5, v6, 3, v5
  s_mul_i32 s3, s29, 640
  s_add_u32 s3, s3, 79872
  v_add_u32 v5, s3, v5
  v_cmp_le_u32 s[36:37], 18, v4
  v_cmp_eq_u32 vcc, 18, v4
  v_mov_b32 v7, 0x3f803f80
  s_nop 0
  v_cndmask_b32 v7, 0, v7, vcc
  v_cmp_gt_u32 vcc, 20, v4
  v_cndmask_b32 v20, v20, v7, s[36:37]
  v_cndmask_b32 v21, v21, v7, s[36:37]
  s_mov_b64 exec, vcc
  ds_write_b64 v5, v[20:21]
  s_mov_b64 exec, -1
L_kvst_28:
  s_waitcnt lgkmcnt(0)
  s_barrier
  s_cmp_lg_u32 s20, 0
  s_cbranch_scc1 L_nkv_23
  v_lshlrev_b32 v4, 4, v2
  v_add_u32 v5, 79872, v4
  ds_read_b128 v[8:11], v5
  ds_read_b128 v[12:15], v5 offset:1024
  s_lshr_b32 s3, s33, 3
  s_mul_i32 s3, s3, 19456
  s_add_u32 s3, s3, 2359296
  s_and_b32 s30, s33, 7
  s_lshl_b32 s31, s30, 10
  s_add_u32 s31, s31, s3
  s_mul_i32 s32, s30, 1280
  s_add_u32 s32, s32, s3
  s_add_u32 s32, s32, 8192
  s_lshl_b32 s30, s30, 7
  s_add_u32 s30, s30, s3
  s_add_u32 s30, s30, 18432
  s_add_u32 s3, s32, 1024
  s_cmp_eq_u32 s34, 0
  s_cselect_b32 s31, s31, s32
  s_cselect_b32 s30, s30, s3
  s_cselect_b32 s36, 0xff, -1
  s_and_b32 s36, s36, 0xffff
  s_mov_b32 s37, 0
  s_waitcnt lgkmcnt(1)
  buffer_store_dwordx4 v[8:11], v4, s[16:19], s31 offen sc1
  s_waitcnt lgkmcnt(0)
  s_mov_b64 exec, s[36:37]
  buffer_store_dwordx4 v[12:15], v4, s[16:19], s30 offen sc1
  s_mov_b64 exec, -1
  v_add_f32 v6, v12, v13
  v_add_f32 v7, v14, v15
  v_max_f32 v6, v6, v7
  v_or_b32 v6, 1, v6
  s_and_b32 s3, s33, 7
  s_lshl_b32 s3, s3, 3
  v_readlane_b32 s30, v6, 8
  s_lshl_b32 s31, s34, 2
  s_add_u32 s3, s3, s31
  s_lshr_b32 s31, s33, 3
  s_lshl_b32 s31, s31, 7
  s_add_u32 s3, s3, s31
  s_add_u32 s3, s3, 14155776
  s_cmp_eq_u32 s34, 0
  s_cselect_b32 s30, s30, 1
  v_lshlrev_b32 v4, 10, v2
  v_add_u32 v4, s3, v4
  v_mov_b32 v5, s30
  s_mov_b64 exec, 0xffff
  s_waitcnt vmcnt(0)
  global_store_dword v4, v5, s[12:13] sc1
  s_mov_b64 exec, -1
  s_branch L_nkv_23
L_kvl_24:
  s_cmp_lg_u32 s2, 256
  s_cbranch_scc1 L_i1_30
  v_lshrrev_b32 v7, 2, v2
  v_lshlrev_b32 v7, 7, v7
  v_and_b32 v8, 3, v2
  v_lshl_add_u32 v7, v8, 4, v7
  v_add_u32 v7, 14155776, v7
  v_mov_b32 v8, 0
  v_mov_b32 v9, 0
  v_mov_b32 v10, 0
  v_mov_b32 v11, 0
  s_mov_b32 s3, 0
  buffer_store_dwordx4 v[8:11], v7, s[16:19], s3 offen sc1
  s_mov_b32 s3, 2048
  buffer_store_dwordx4 v[8:11], v7, s[16:19], s3 offen sc1
  s_mov_b32 s3, 4096
  buffer_store_dwordx4 v[8:11], v7, s[16:19], s3 offen sc1
  s_mov_b32 s3, 6144
  buffer_store_dwordx4 v[8:11], v7, s[16:19], s3 offen sc1
  s_mov_b32 s3, 8192
  buffer_store_dwordx4 v[8:11], v7, s[16:19], s3 offen sc1
  s_mov_b32 s3, 10240
  buffer_store_dwordx4 v[8:11], v7, s[16:19], s3 offen sc1
  s_mov_b32 s3, 12288
  buffer_store_dwordx4 v[8:11], v7, s[16:19], s3 offen sc1
  s_mov_b32 s3, 14336
  buffer_store_dwordx4 v[8:11], v7, s[16:19], s3 offen sc1
  v_mov_b32 v6, 1
  s_mov_b64 exec, 1
  s_waitcnt vmcnt(0)
  global_store_dword v8, v6, s[14:15] offset:128 sc1
  s_mov_b64 exec, -1
L_i1_30:
  v_mov_b32 v24, 0
  v_mov_b32 v25, 0
  v_mov_b32 v26, 0
  v_mov_b32 v27, 0
  v_mov_b32 v22, 1
  s_cmp_lg_u32 s2, 300
  s_cbranch_scc1 L_noinit_31
  v_lshlrev_b32 v20, 8, v2
  v_add_u32 v20, 13631488, v20
  s_mov_b32 s3, 16384
  s_mov_b32 s30, 32768
  buffer_store_dword v24, v20, s[16:19], 0 offen sc1
  buffer_store_dword v24, v20, s[16:19], s3 offen sc1
  v_lshrrev_b32 v21, 1, v2
  v_lshlrev_b32 v21, 7, v21
  v_and_b32 v23, 1, v2
  v_lshl_add_u32 v21, v23, 4, v21
  v_add_u32 v21, 14218240, v21
  s_mov_b32 s3, 4096
  s_mov_b32 s31, 8192
  buffer_store_dwordx4 v[24:27], v21, s[16:19], 0 offen sc1
  buffer_store_dwordx4 v[24:27], v21, s[16:19], s3 offen sc1
  buffer_store_dwordx4 v[24:27], v21, s[16:19], s31 offen sc1
  s_mov_b64 exec, 1
  buffer_store_dword v24, v20, s[16:19], s30 offen sc1
  s_waitcnt vmcnt(0)
  global_store_dword v24, v22, s[14:15] sc1
  s_mov_b64 exec, -1
L_noinit_31:
  s_cmp_lg_u32 s2, 301
  s_cbranch_scc1 L_noinit2_32
  v_lshlrev_b32 v23, 4, v2
  v_add_u32 v23, 14201856, v23
  s_mov_b32 s3, 0
  buffer_store_dwordx4 v[24:27], v23, s[16:19], s3 offen offset:0 sc1
  buffer_store_dwordx4 v[24:27], v23, s[16:19], s3 offen offset:1024 sc1
  buffer_store_dwordx4 v[24:27], v23, s[16:19], s3 offen offset:2048 sc1
  buffer_store_dwordx4 v[24:27], v23, s[16:19], s3 offen offset:3072 sc1
  s_mov_b32 s3, 4096
  buffer_store_dwordx4 v[24:27], v23, s[16:19], s3 offen offset:0 sc1
  buffer_store_dwordx4 v[24:27], v23, s[16:19], s3 offen offset:1024 sc1
  buffer_store_dwordx4 v[24:27], v23, s[16:19], s3 offen offset:2048 sc1
  buffer_store_dwordx4 v[24:27], v23, s[16:19], s3 offen offset:3072 sc1
  s_mov_b32 s3, 8192
  buffer_store_dwordx4 v[24:27], v23, s[16:19], s3 offen offset:0 sc1
  buffer_store_dwordx4 v[24:27], v23, s[16:19], s3 offen offset:1024 sc1
  buffer_store_dwordx4 v[24:27], v23, s[16:19], s3 offen offset:2048 sc1
  buffer_store_dwordx4 v[24:27], v23, s[16:19], s3 offen offset:3072 sc1
  s_mov_b32 s3, 12288
  buffer_store_dwordx4 v[24:27], v23, s[16:19], s3 offen offset:0 sc1
  buffer_store_dwordx4 v[24:27], v23, s[16:19], s3 offen offset:1024 sc1
  buffer_store_dwordx4 v[24:27], v23, s[16:19], s3 offen offset:2048 sc1
  buffer_store_dwordx4 v[24:27], v23, s[16:19], s3 offen offset:3072 sc1
  s_mov_b64 exec, 1
  s_waitcnt vmcnt(0)
  global_store_dword v24, v22, s[14:15] offset:132 sc1
  s_mov_b64 exec, -1
L_noinit2_32:
  s_barrier
  s_barrier
  s_barrier
  v_mov_b32 v10, 128
  global_load_dword v11, v10, s[14:15]
  s_waitcnt vmcnt(0)
  v_readfirstlane_b32 s31, v11
  s_nop 3
  s_cmp_lg_u32 s31, 0
  s_cbranch_scc1 L_rdy_33
  s_sleep 12
  s_mov_b32 s31, 0x10000
L_pl_34:
  global_load_dword v11, v10, s[14:15] sc1
  s_waitcnt vmcnt(0)
  v_cmp_eq_u32 vcc, 0, v11
  s_sub_u32 s31, s31, 1
  s_cbranch_scc1 L_pd_35
  s_nop 2
  s_cmp_eq_u64 vcc, 0
  s_cbranch_scc1 L_pd_35
  s_sleep 12
  s_branch L_pl_34
L_pd_35:
L_rdy_33:
  s_barrier
L_nkv_23:
  v_lshlrev_b32 v4, 4, v2
  v_mov_b32 v8, 0
  v_mov_b32 v9, 0
  v_mov_b32 v10, 0
  v_mov_b32 v11, 0
  s_cmp_eq_u32 s20, 4
  s_cbranch_scc1 L_cvx_21
  s_setprio 2
  s_load_dwordx16 s[44:59], s[0:1], 8
  s_lshr_b32 s3, s20, 1
  s_lshl_b32 s23, s22, 1
  s_add_u32 s23, s23, s21
  s_lshl_b32 s43, s23, 1
  s_add_u32 s23, s23, s3
  s_mul_i32 s28, s3, 31680
  s_mul_i32 s27, s3, 4608
  s_add_u32 s27, s27, 63488
  s_and_b32 s26, s20, 1
  s_lshl_b32 s33, s26, 1
  s_waitcnt lgkmcnt(0)
  s_add_u32 s42, s33, 1
  s_mov_b32 s24, s23
  s_mov_b32 s25, 0
  s_sub_u32 s30, s2, 384
  s_cmp_ge_u32 s30, 32
  s_cbranch_scc1 L_kgr_36
  s_mov_b32 s25, 1
  s_lshl_b32 s31, s30, 1
  s_lshr_b32 s3, s20, 1
  s_add_u32 s31, s31, s3
  s_lshr_b32 s23, s31, 3
  s_mul_i32 s23, s23, 72
  s_and_b32 s31, s31, 7
  s_add_u32 s23, s23, s31
  s_add_u32 s23, s23, 64
L_kgr_36:
  v_lshlrev_b32 v28, 2, v2
  s_lshl_b32 s3, s23, 8
  v_add_u32 v29, s3, v28
  s_lshl_b32 s36, s23, 1
  v_mov_b32 v31, s36
  global_load_ushort v26, v31, s[56:57]
  global_load_dword v20, v29, s[44:45]
  global_load_dword v21, v29, s[46:47]
  global_load_dword v22, v29, s[48:49]
  global_load_dword v23, v29, s[50:51]
  global_load_dword v24, v29, s[52:53]
  global_load_dword v25, v29, s[54:55]
  global_load_ushort v27, v31, s[58:59]
  v_and_b32 v85, 15, v2
  v_lshrrev_b32 v86, 4, v2
  v_lshlrev_b32 v84, 3, v2
  v_add_u32 v84, s28, v84
  v_cmp_le_u32 vcc, 12, v85
  v_cmp_le_u32 s[36:37], 4, v85
  v_cmp_le_u32 s[38:39], 8, v85
  v_subb_co_u32 v28, vcc, v85, 0, vcc
  v_subb_co_u32 v29, s[36:37], v85, 0, s[36:37]
  s_lshl_b32 s3, s26, 4
  v_subb_co_u32 v29, s[38:39], v29, 0, s[38:39]
  v_add_u32 v28, 32, v28
  v_add_u32 v29, 46, v29
  v_add_u32 v30, s3, v85
  v_lshlrev_b32 v31, 4, v86
  v_add_u32 v31, s28, v31
  v_mul_u32_u24 v87, 528, v28
  v_mul_u32_u24 v88, 528, v29
  v_mul_u32_u24 v89, 528, v30
  v_add_u32 v87, v87, v31
  v_add_u32 v88, v88, v31
  v_add_u32 v89, v89, v31
  v_cmp_le_u32 s[36:37], 2, v86
  v_and_b32 v33, 1, v85
  v_cmp_eq_u32 s[38:39], 1, v33
  v_or_b32 v28, s3, v2
  v_cmp_eq_u32 s[40:41], 0, v28
  v_mov_b32 v92, 0x3020100
  v_mov_b32 v32, 0x1000100
  v_cndmask_b32 v92, v92, v32, s[36:37]
  v_mov_b32 v93, 0x7060504
  v_mov_b32 v32, 0x5040302
  v_cndmask_b32 v93, v93, v32, s[36:37]
  v_mov_b32 v94, 0x1000100
  v_mov_b32 v96, 0x3020100
  v_mov_b32 v32, 0x3020302
  v_cndmask_b32 v96, v96, v32, s[38:39]
  v_mov_b32 v32, 0x3020302
  v_cndmask_b32 v96, v32, v96, s[36:37]
  v_mov_b32 v97, 0x5040504
  v_mov_b32 v32, 0x3020302
  v_cndmask_b32 v97, v97, v32, s[36:37]
  v_mov_b32 v98, 0x5040504
  v_mov_b32 v99, 0x7060504
  v_mov_b32 v32, 0x7060706
  v_cndmask_b32 v99, v99, v32, s[38:39]
  v_mov_b32 v100, 0x7060706
  v_lshlrev_b32 v30, 4, v30
  v_and_b32 v28, 1, v86
  v_lshl_add_u32 v104, v28, 3, v30
  v_lshrrev_b32 v28, 1, v86
  v_lshl_add_u32 v104, v28, 9, v104
  v_add_u32 v104, 4980752, v104
  v_lshlrev_b32 v28, 9, v86
  v_add_u32 v28, 1024, v28
  v_lshlrev_b32 v29, 10, v86
  v_cndmask_b32 v28, v28, v29, s[36:37]
  v_add_u32 v105, v28, v30
  v_add_u32 v105, 4980752, v105
  v_mov_b32 v28, 0x40000000
  v_cndmask_b32 v106, v28, v105, s[36:37]
  v_mov_b32 v107, 4980736
  v_cndmask_b32 v107, v28, v107, s[40:41]
  s_waitcnt vmcnt(0)
  v_lshlrev_b32 v28, 16, v26
  v_mul_f32 v28, 0x3fb8aa3b, v28
  v_exp_f32 v28, v28
  v_lshlrev_b32 v40, 16, v20
  v_cvt_pk_bf16_f32 v28, v28, v28
  v_and_b32 v42, 0xffff0000, v20
  v_and_b32 v28, 0xffff0000, v28
  v_lshlrev_b32 v41, 16, v21
  v_and_b32 v43, 0xffff0000, v21
  v_mul_f32 v40, v28, v40
  v_mul_f32 v41, v28, v41
  v_mul_f32 v40, 0x3fb8aa3b, v40
  v_mul_f32 v41, 0x3e22f983, v41
  v_mul_f32 v42, v28, v42
  v_mul_f32 v43, v28, v43
  v_mul_f32 v42, 0x3fb8aa3b, v42
  v_mul_f32 v43, 0x3e22f983, v43
  s_cmp_lg_u32 s26, 0
  s_cbranch_scc1 L_roleE_38
  v_mul_f32 v32, 0x41000000, v40
  v_mul_f32 v33, 0x41000000, v41
  v_exp_f32 v32, v32
  v_rndne_f32 v34, v33
  v_sub_f32 v33, v33, v34
  v_cos_f32 v34, v33
  v_sin_f32 v35, v33
  v_mul_f32 v36, 0x41000000, v42
  v_mul_f32 v37, 0x41000000, v43
  v_exp_f32 v36, v36
  v_rndne_f32 v38, v37
  v_sub_f32 v37, v37, v38
  v_cos_f32 v38, v37
  v_sin_f32 v39, v37
  v_mul_f32 v56, v32, v34
  v_mul_f32 v57, v32, v35
  v_mul_f32 v58, v36, v38
  v_mul_f32 v59, v36, v39
  v_mov_b32 v80, 0x3f80
  v_mov_b32 v81, 0x3f80
  ds_write_b64 v84, v[80:81]
  v_cvt_pk_bf16_f32 v82, v56, v57
  v_cvt_pk_bf16_f32 v83, v58, v59
  ds_write_b64 v84, v[82:83] offset:528
  v_mul_f32 v76, v57, v57
  v_mul_f32 v77, v57, v56
  v_mul_f32 v78, v59, v59
  v_mul_f32 v79, v59, v58
  v_fma_f32 v65, v56, v57, v77
  v_fma_f32 v64, v56, v56, -v76
  v_fma_f32 v67, v58, v59, v79
  v_fma_f32 v66, v58, v58, -v78
  v_cvt_pk_bf16_f32 v80, v64, v65
  v_cvt_pk_bf16_f32 v81, v66, v67
  ds_write_b64 v84, v[80:81] offset:1056
  v_mul_f32 v76, v65, v57
  v_mul_f32 v77, v65, v56
  v_mul_f32 v78, v67, v59
  v_mul_f32 v79, v67, v58
  v_fma_f32 v69, v64, v57, v77
  v_fma_f32 v68, v64, v56, -v76
  v_fma_f32 v71, v66, v59, v79
  v_fma_f32 v70, v66, v58, -v78
  v_cvt_pk_bf16_f32 v82, v68, v69
  v_cvt_pk_bf16_f32 v83, v70, v71
  ds_write_b64 v84, v[82:83] offset:1584
  v_mul_f32 v76, v69, v57
  v_mul_f32 v77, v69, v56
  v_mul_f32 v78, v71, v59
  v_mul_f32 v79, v71, v58
  v_fma_f32 v65, v68, v57, v77
  v_fma_f32 v64, v68, v56, -v76
  v_fma_f32 v67, v70, v59, v79
  v_fma_f32 v66, v70, v58, -v78
  v_cvt_pk_bf16_f32 v80, v64, v65
  v_cvt_pk_bf16_f32 v81, v66, v67
  ds_write_b64 v84, v[80:81] offset:2112
  v_mul_f32 v76, v65, v57
  v_mul_f32 v77, v65, v56
  v_mul_f32 v78, v67, v59
  v_mul_f32 v79, v67, v58
  v_fma_f32 v69, v64, v57, v77
  v_fma_f32 v68, v64, v56, -v76
  v_fma_f32 v71, v66, v59, v79
  v_fma_f32 v70, v66, v58, -v78
  v_cvt_pk_bf16_f32 v82, v68, v69
  v_cvt_pk_bf16_f32 v83, v70, v71
  ds_write_b64 v84, v[82:83] offset:2640
  v_mul_f32 v76, v69, v57
  v_mul_f32 v77, v69, v56
  v_mul_f32 v78, v71, v59
  v_mul_f32 v79, v71, v58
  v_fma_f32 v65, v68, v57, v77
  v_fma_f32 v64, v68, v56, -v76
  v_fma_f32 v67, v70, v59, v79
  v_fma_f32 v66, v70, v58, -v78
  v_cvt_pk_bf16_f32 v80, v64, v65
  v_cvt_pk_bf16_f32 v81, v66, v67
  ds_write_b64 v84, v[80:81] offset:3168
  v_mul_f32 v76, v65, v57
  v_mul_f32 v77, v65, v56
  v_mul_f32 v78, v67, v59
  v_mul_f32 v79, v67, v58
  v_fma_f32 v69, v64, v57, v77
  v_fma_f32 v68, v64, v56, -v76
  v_fma_f32 v71, v66, v59, v79
  v_fma_f32 v70, v66, v58, -v78
  v_cvt_pk_bf16_f32 v82, v68, v69
  v_cvt_pk_bf16_f32 v83, v70, v71
  ds_write_b64 v84, v[82:83] offset:3696
  v_mul_f32 v76, v69, v57
  v_mul_f32 v77, v69, v56
  v_mul_f32 v78, v71, v59
  v_mul_f32 v79, v71, v58
  v_fma_f32 v65, v68, v57, v77
  v_fma_f32 v64, v68, v56, -v76
  v_fma_f32 v67, v70, v59, v79
  v_fma_f32 v66, v70, v58, -v78
  v_cvt_pk_bf16_f32 v80, v64, v65
  v_cvt_pk_bf16_f32 v81, v66, v67
  ds_write_b64 v84, v[80:81] offset:4224
  v_mul_f32 v76, v65, v57
  v_mul_f32 v77, v65, v56
  v_mul_f32 v78, v67, v59
  v_mul_f32 v79, v67, v58
  v_fma_f32 v69, v64, v57, v77
  v_fma_f32 v68, v64, v56, -v76
  v_fma_f32 v71, v66, v59, v79
  v_fma_f32 v70, v66, v58, -v78
  v_cvt_pk_bf16_f32 v82, v68, v69
  v_cvt_pk_bf16_f32 v83, v70, v71
  ds_write_b64 v84, v[82:83] offset:4752
  v_mul_f32 v76, v69, v57
  v_mul_f32 v77, v69, v56
  v_mul_f32 v78, v71, v59
  v_mul_f32 v79, v71, v58
  v_fma_f32 v65, v68, v57, v77
  v_fma_f32 v64, v68, v56, -v76
  v_fma_f32 v67, v70, v59, v79
  v_fma_f32 v66, v70, v58, -v78
  v_cvt_pk_bf16_f32 v80, v64, v65
  v_cvt_pk_bf16_f32 v81, v66, v67
  ds_write_b64 v84, v[80:81] offset:5280
  v_mul_f32 v76, v65, v57
  v_mul_f32 v77, v65, v56
  v_mul_f32 v78, v67, v59
  v_mul_f32 v79, v67, v58
  v_fma_f32 v69, v64, v57, v77
  v_fma_f32 v68, v64, v56, -v76
  v_fma_f32 v71, v66, v59, v79
  v_fma_f32 v70, v66, v58, -v78
  v_cvt_pk_bf16_f32 v82, v68, v69
  v_cvt_pk_bf16_f32 v83, v70, v71
  ds_write_b64 v84, v[82:83] offset:5808
  v_mul_f32 v76, v69, v57
  v_mul_f32 v77, v69, v56
  v_mul_f32 v78, v71, v59
  v_mul_f32 v79, v71, v58
  v_fma_f32 v65, v68, v57, v77
  v_fma_f32 v64, v68, v56, -v76
  v_fma_f32 v67, v70, v59, v79
  v_fma_f32 v66, v70, v58, -v78
  v_cvt_pk_bf16_f32 v80, v64, v65
  v_cvt_pk_bf16_f32 v81, v66, v67
  ds_write_b64 v84, v[80:81] offset:6336
  v_mul_f32 v76, v65, v57
  v_mul_f32 v77, v65, v56
  v_mul_f32 v78, v67, v59
  v_mul_f32 v79, v67, v58
  v_fma_f32 v69, v64, v57, v77
  v_fma_f32 v68, v64, v56, -v76
  v_fma_f32 v71, v66, v59, v79
  v_fma_f32 v70, v66, v58, -v78
  v_cvt_pk_bf16_f32 v82, v68, v69
  v_cvt_pk_bf16_f32 v83, v70, v71
  ds_write_b64 v84, v[82:83] offset:6864
  v_mul_f32 v76, v69, v57
  v_mul_f32 v77, v69, v56
  v_mul_f32 v78, v71, v59
  v_mul_f32 v79, v71, v58
  v_fma_f32 v65, v68, v57, v77
  v_fma_f32 v64, v68, v56, -v76
  v_fma_f32 v67, v70, v59, v79
  v_fma_f32 v66, v70, v58, -v78
  v_cvt_pk_bf16_f32 v80, v64, v65
  v_cvt_pk_bf16_f32 v81, v66, v67
  ds_write_b64 v84, v[80:81] offset:7392
  v_mul_f32 v76, v65, v57
  v_mul_f32 v77, v65, v56
  v_mul_f32 v78, v67, v59
  v_mul_f32 v79, v67, v58
  v_fma_f32 v69, v64, v57, v77
  v_fma_f32 v68, v64, v56, -v76
  v_fma_f32 v71, v66, v59, v79
  v_fma_f32 v70, v66, v58, -v78
  v_cvt_pk_bf16_f32 v82, v68, v69
  v_cvt_pk_bf16_f32 v83, v70, v71
  ds_write_b64 v84, v[82:83] offset:7920
  v_mul_f32 v76, v69, v57
  v_mul_f32 v77, v69, v56
  v_mul_f32 v78, v71, v59
  v_mul_f32 v79, v71, v58
  v_fma_f32 v65, v68, v57, v77
  v_fma_f32 v64, v68, v56, -v76
  v_fma_f32 v67, v70, v59, v79
  v_fma_f32 v66, v70, v58, -v78
  v_cvt_pk_bf16_f32 v80, v64, v65
  v_cvt_pk_bf16_f32 v81, v66, v67
  ds_write_b64 v84, v[80:81] offset:8448
  v_mul_f32 v76, v65, v57
  v_mul_f32 v77, v65, v56
  v_mul_f32 v78, v67, v59
  v_mul_f32 v79, v67, v58
  v_fma_f32 v69, v64, v57, v77
  v_fma_f32 v68, v64, v56, -v76
  v_fma_f32 v71, v66, v59, v79
  v_fma_f32 v70, v66, v58, -v78
  v_cvt_pk_bf16_f32 v82, v68, v69
  v_cvt_pk_bf16_f32 v83, v70, v71
  ds_write_b64 v84, v[82:83] offset:8976
  v_mul_f32 v76, v69, v57
  v_mul_f32 v77, v69, v56
  v_mul_f32 v78, v71, v59
  v_mul_f32 v79, v71, v58
  v_fma_f32 v65, v68, v57, v77
  v_fma_f32 v64, v68, v56, -v76
  v_fma_f32 v67, v70, v59, v79
  v_fma_f32 v66, v70, v58, -v78
  v_cvt_pk_bf16_f32 v80, v64, v65
  v_cvt_pk_bf16_f32 v81, v66, v67
  ds_write_b64 v84, v[80:81] offset:9504
  v_mul_f32 v76, v65, v57
  v_mul_f32 v77, v65, v56
  v_mul_f32 v78, v67, v59
  v_mul_f32 v79, v67, v58
  v_fma_f32 v69, v64, v57, v77
  v_fma_f32 v68, v64, v56, -v76
  v_fma_f32 v71, v66, v59, v79
  v_fma_f32 v70, v66, v58, -v78
  v_cvt_pk_bf16_f32 v82, v68, v69
  v_cvt_pk_bf16_f32 v83, v70, v71
  ds_write_b64 v84, v[82:83] offset:10032
  v_mul_f32 v76, v69, v57
  v_mul_f32 v77, v69, v56
  v_mul_f32 v78, v71, v59
  v_mul_f32 v79, v71, v58
  v_fma_f32 v65, v68, v57, v77
  v_fma_f32 v64, v68, v56, -v76
  v_fma_f32 v67, v70, v59, v79
  v_fma_f32 v66, v70, v58, -v78
  v_cvt_pk_bf16_f32 v80, v64, v65
  v_cvt_pk_bf16_f32 v81, v66, v67
  ds_write_b64 v84, v[80:81] offset:10560
  v_mul_f32 v76, v65, v57
  v_mul_f32 v77, v65, v56
  v_mul_f32 v78, v67, v59
  v_mul_f32 v79, v67, v58
  v_fma_f32 v69, v64, v57, v77
  v_fma_f32 v68, v64, v56, -v76
  v_fma_f32 v71, v66, v59, v79
  v_fma_f32 v70, v66, v58, -v78
  v_cvt_pk_bf16_f32 v82, v68, v69
  v_cvt_pk_bf16_f32 v83, v70, v71
  ds_write_b64 v84, v[82:83] offset:11088
  v_mul_f32 v76, v69, v57
  v_mul_f32 v77, v69, v56
  v_mul_f32 v78, v71, v59
  v_mul_f32 v79, v71, v58
  v_fma_f32 v65, v68, v57, v77
  v_fma_f32 v64, v68, v56, -v76
  v_fma_f32 v67, v70, v59, v79
  v_fma_f32 v66, v70, v58, -v78
  v_cvt_pk_bf16_f32 v80, v64, v65
  v_cvt_pk_bf16_f32 v81, v66, v67
  ds_write_b64 v84, v[80:81] offset:11616
  v_mul_f32 v76, v65, v57
  v_mul_f32 v77, v65, v56
  v_mul_f32 v78, v67, v59
  v_mul_f32 v79, v67, v58
  v_fma_f32 v69, v64, v57, v77
  v_fma_f32 v68, v64, v56, -v76
  v_fma_f32 v71, v66, v59, v79
  v_fma_f32 v70, v66, v58, -v78
  v_cvt_pk_bf16_f32 v82, v68, v69
  v_cvt_pk_bf16_f32 v83, v70, v71
  ds_write_b64 v84, v[82:83] offset:12144
  v_mul_f32 v76, v69, v57
  v_mul_f32 v77, v69, v56
  v_mul_f32 v78, v71, v59
  v_mul_f32 v79, v71, v58
  v_fma_f32 v65, v68, v57, v77
  v_fma_f32 v64, v68, v56, -v76
  v_fma_f32 v67, v70, v59, v79
  v_fma_f32 v66, v70, v58, -v78
  v_cvt_pk_bf16_f32 v80, v64, v65
  v_cvt_pk_bf16_f32 v81, v66, v67
  ds_write_b64 v84, v[80:81] offset:12672
  v_mul_f32 v76, v65, v57
  v_mul_f32 v77, v65, v56
  v_mul_f32 v78, v67, v59
  v_mul_f32 v79, v67, v58
  v_fma_f32 v69, v64, v57, v77
  v_fma_f32 v68, v64, v56, -v76
  v_fma_f32 v71, v66, v59, v79
  v_fma_f32 v70, v66, v58, -v78
  v_cvt_pk_bf16_f32 v82, v68, v69
  v_cvt_pk_bf16_f32 v83, v70, v71
  ds_write_b64 v84, v[82:83] offset:13200
  v_mul_f32 v76, v69, v57
  v_mul_f32 v77, v69, v56
  v_mul_f32 v78, v71, v59
  v_mul_f32 v79, v71, v58
  v_fma_f32 v65, v68, v57, v77
  v_fma_f32 v64, v68, v56, -v76
  v_fma_f32 v67, v70, v59, v79
  v_fma_f32 v66, v70, v58, -v78
  v_cvt_pk_bf16_f32 v80, v64, v65
  v_cvt_pk_bf16_f32 v81, v66, v67
  ds_write_b64 v84, v[80:81] offset:13728
  v_mul_f32 v76, v65, v57
  v_mul_f32 v77, v65, v56
  v_mul_f32 v78, v67, v59
  v_mul_f32 v79, v67, v58
  v_fma_f32 v69, v64, v57, v77
  v_fma_f32 v68, v64, v56, -v76
  v_fma_f32 v71, v66, v59, v79
  v_fma_f32 v70, v66, v58, -v78
  v_cvt_pk_bf16_f32 v82, v68, v69
  v_cvt_pk_bf16_f32 v83, v70, v71
  ds_write_b64 v84, v[82:83] offset:14256
  v_mul_f32 v76, v69, v57
  v_mul_f32 v77, v69, v56
  v_mul_f32 v78, v71, v59
  v_mul_f32 v79, v71, v58
  v_fma_f32 v65, v68, v57, v77
  v_fma_f32 v64, v68, v56, -v76
  v_fma_f32 v67, v70, v59, v79
  v_fma_f32 v66, v70, v58, -v78
  v_cvt_pk_bf16_f32 v80, v64, v65
  v_cvt_pk_bf16_f32 v81, v66, v67
  ds_write_b64 v84, v[80:81] offset:14784
  v_mul_f32 v76, v65, v57
  v_mul_f32 v77, v65, v56
  v_mul_f32 v78, v67, v59
  v_mul_f32 v79, v67, v58
  v_fma_f32 v69, v64, v57, v77
  v_fma_f32 v68, v64, v56, -v76
  v_fma_f32 v71, v66, v59, v79
  v_fma_f32 v70, v66, v58, -v78
  v_cvt_pk_bf16_f32 v82, v68, v69
  v_cvt_pk_bf16_f32 v83, v70, v71
  ds_write_b64 v84, v[82:83] offset:15312
  v_mul_f32 v76, v69, v57
  v_mul_f32 v77, v69, v56
  v_mul_f32 v78, v71, v59
  v_mul_f32 v79, v71, v58
  v_fma_f32 v65, v68, v57, v77
  v_fma_f32 v64, v68, v56, -v76
  v_fma_f32 v67, v70, v59, v79
  v_fma_f32 v66, v70, v58, -v78
  v_cvt_pk_bf16_f32 v80, v64, v65
  v_cvt_pk_bf16_f32 v81, v66, v67
  ds_write_b64 v84, v[80:81] offset:15840
  v_mul_f32 v76, v65, v57
  v_mul_f32 v77, v65, v56
  v_mul_f32 v78, v67, v59
  v_mul_f32 v79, v67, v58
  v_fma_f32 v69, v64, v57, v77
  v_fma_f32 v68, v64, v56, -v76
  v_fma_f32 v71, v66, v59, v79
  v_fma_f32 v70, v66, v58, -v78
  v_cvt_pk_bf16_f32 v82, v68, v69
  v_cvt_pk_bf16_f32 v83, v70, v71
  ds_write_b64 v84, v[82:83] offset:16368
  s_branch L_gend_39
L_roleE_38:
  v_lshlrev_b32 v68, 16, v22
  v_and_b32 v70, 0xffff0000, v22
  v_lshlrev_b32 v69, 16, v23
  v_and_b32 v71, 0xffff0000, v23
  v_lshlrev_b32 v72, 16, v24
  v_and_b32 v74, 0xffff0000, v24
  v_lshlrev_b32 v73, 16, v25
  v_and_b32 v75, 0xffff0000, v25
  v_mul_f32 v68, v28, v68
  v_mul_f32 v69, v28, v69
  v_mul_f32 v70, v28, v70
  v_mul_f32 v71, v28, v71
  v_mul_f32 v76, v73, v69
  v_mul_f32 v77, v73, v68
  v_mul_f32 v78, v75, v71
  v_mul_f32 v79, v75, v70
  v_fma_f32 v65, v72, v69, v77
  v_fma_f32 v64, v72, v68, -v76
  v_fma_f32 v67, v74, v71, v79
  v_fma_f32 v66, v74, v70, -v78
  v_mul_f32 v32, 0x3f800000, v40
  v_mul_f32 v33, 0x3f800000, v41
  v_exp_f32 v32, v32
  v_rndne_f32 v34, v33
  v_sub_f32 v33, v33, v34
  v_cos_f32 v34, v33
  v_sin_f32 v35, v33
  v_mul_f32 v36, 0x3f800000, v42
  v_mul_f32 v37, 0x3f800000, v43
  v_exp_f32 v36, v36
  v_rndne_f32 v38, v37
  v_sub_f32 v37, v37, v38
  v_cos_f32 v38, v37
  v_sin_f32 v39, v37
  v_mul_f32 v44, v32, v34
  v_mul_f32 v45, v32, v35
  v_mul_f32 v46, v36, v38
  v_mul_f32 v47, v36, v39
  v_mul_f32 v32, 0x43800000, v40
  v_mul_f32 v33, 0x43800000, v41
  v_exp_f32 v32, v32
  v_rndne_f32 v34, v33
  v_sub_f32 v33, v33, v34
  v_cos_f32 v34, v33
  v_sin_f32 v35, v33
  v_mul_f32 v36, 0x43800000, v42
  v_mul_f32 v37, 0x43800000, v43
  v_exp_f32 v36, v36
  v_rndne_f32 v38, v37
  v_sub_f32 v37, v37, v38
  v_cos_f32 v38, v37
  v_sin_f32 v39, v37
  v_mul_f32 v60, v32, v34
  v_mul_f32 v61, v32, v35
  v_mul_f32 v62, v36, v38
  v_mul_f32 v63, v36, v39
  v_cvt_pk_bf16_f32 v80, v64, -v65
  v_cvt_pk_bf16_f32 v81, v66, -v67
  ds_write_b64 v84, v[80:81] offset:16896
  v_mul_f32 v76, v45, v45
  v_mul_f32 v77, v45, v44
  v_mul_f32 v78, v47, v47
  v_mul_f32 v79, v47, v46
  v_fma_f32 v49, v44, v45, v77
  v_fma_f32 v48, v44, v44, -v76
  v_fma_f32 v51, v46, v47, v79
  v_fma_f32 v50, v46, v46, -v78
  v_mul_f32 v76, v49, v49
  v_mul_f32 v77, v49, v48
  v_mul_f32 v78, v51, v51
  v_mul_f32 v79, v51, v50
  v_fma_f32 v53, v48, v49, v77
  v_fma_f32 v52, v48, v48, -v76
  v_fma_f32 v55, v50, v51, v79
  v_fma_f32 v54, v50, v50, -v78
  v_mul_f32 v76, v53, v53
  v_mul_f32 v77, v53, v52
  v_mul_f32 v78, v55, v55
  v_mul_f32 v79, v55, v54
  v_fma_f32 v57, v52, v53, v77
  v_fma_f32 v56, v52, v52, -v76
  v_fma_f32 v59, v54, v55, v79
  v_fma_f32 v58, v54, v54, -v78
  v_mul_f32 v76, v65, v45
  v_mul_f32 v77, v65, v44
  v_mul_f32 v78, v67, v47
  v_mul_f32 v79, v67, v46
  v_fma_f32 v69, v64, v45, v77
  v_fma_f32 v68, v64, v44, -v76
  v_fma_f32 v71, v66, v47, v79
  v_fma_f32 v70, v66, v46, -v78
  v_cvt_pk_bf16_f32 v82, v68, -v69
  v_cvt_pk_bf16_f32 v83, v70, -v71
  ds_write_b64 v84, v[82:83] offset:17424
  v_mul_f32 v76, v69, v45
  v_mul_f32 v77, v69, v44
  v_mul_f32 v78, v71, v47
  v_mul_f32 v79, v71, v46
  v_fma_f32 v73, v68, v45, v77
  v_fma_f32 v72, v68, v44, -v76
  v_fma_f32 v75, v70, v47, v79
  v_fma_f32 v74, v70, v46, -v78
  v_cvt_pk_bf16_f32 v80, v72, -v73
  v_cvt_pk_bf16_f32 v81, v74, -v75
  ds_write_b64 v84, v[80:81] offset:17952
  v_mul_f32 v76, v73, v45
  v_mul_f32 v77, v73, v44
  v_mul_f32 v78, v75, v47
  v_mul_f32 v79, v75, v46
  v_fma_f32 v69, v72, v45, v77
  v_fma_f32 v68, v72, v44, -v76
  v_fma_f32 v71, v74, v47, v79
  v_fma_f32 v70, v74, v46, -v78
  v_cvt_pk_bf16_f32 v82, v68, -v69
  v_cvt_pk_bf16_f32 v83, v70, -v71
  ds_write_b64 v84, v[82:83] offset:18480
  v_mul_f32 v76, v69, v45
  v_mul_f32 v77, v69, v44
  v_mul_f32 v78, v71, v47
  v_mul_f32 v79, v71, v46
  v_fma_f32 v73, v68, v45, v77
  v_fma_f32 v72, v68, v44, -v76
  v_fma_f32 v75, v70, v47, v79
  v_fma_f32 v74, v70, v46, -v78
  v_cvt_pk_bf16_f32 v80, v72, -v73
  v_cvt_pk_bf16_f32 v81, v74, -v75
  ds_write_b64 v84, v[80:81] offset:19008
  v_mul_f32 v76, v73, v45
  v_mul_f32 v77, v73, v44
  v_mul_f32 v78, v75, v47
  v_mul_f32 v79, v75, v46
  v_fma_f32 v69, v72, v45, v77
  v_fma_f32 v68, v72, v44, -v76
  v_fma_f32 v71, v74, v47, v79
  v_fma_f32 v70, v74, v46, -v78
  v_cvt_pk_bf16_f32 v82, v68, -v69
  v_cvt_pk_bf16_f32 v83, v70, -v71
  ds_write_b64 v84, v[82:83] offset:19536
  v_mul_f32 v76, v69, v45
  v_mul_f32 v77, v69, v44
  v_mul_f32 v78, v71, v47
  v_mul_f32 v79, v71, v46
  v_fma_f32 v73, v68, v45, v77
  v_fma_f32 v72, v68, v44, -v76
  v_fma_f32 v75, v70, v47, v79
  v_fma_f32 v74, v70, v46, -v78
  v_cvt_pk_bf16_f32 v80, v72, -v73
  v_cvt_pk_bf16_f32 v81, v74, -v75
  ds_write_b64 v84, v[80:81] offset:20064
  v_mul_f32 v76, v73, v45
  v_mul_f32 v77, v73, v44
  v_mul_f32 v78, v75, v47
  v_mul_f32 v79, v75, v46
  v_fma_f32 v69, v72, v45, v77
  v_fma_f32 v68, v72, v44, -v76
  v_fma_f32 v71, v74, v47, v79
  v_fma_f32 v70, v74, v46, -v78
  v_cvt_pk_bf16_f32 v82, v68, -v69
  v_cvt_pk_bf16_f32 v83, v70, -v71
  ds_write_b64 v84, v[82:83] offset:20592
  v_mul_f32 v76, v65, v61
  v_mul_f32 v77, v65, v60
  v_mul_f32 v78, v67, v63
  v_mul_f32 v79, v67, v62
  v_fma_f32 v65, v64, v61, v77
  v_fma_f32 v64, v64, v60, -v76
  v_fma_f32 v67, v66, v63, v79
  v_fma_f32 v66, v66, v62, -v78
  v_cvt_pk_bf16_f32 v80, v64, -v65
  v_cvt_pk_bf16_f32 v81, v66, -v67
  ds_write_b64 v84, v[80:81] offset:21120
  v_mul_f32 v76, v65, v49
  v_mul_f32 v77, v65, v48
  v_mul_f32 v78, v67, v51
  v_mul_f32 v79, v67, v50
  v_fma_f32 v69, v64, v49, v77
  v_fma_f32 v68, v64, v48, -v76
  v_fma_f32 v71, v66, v51, v79
  v_fma_f32 v70, v66, v50, -v78
  v_cvt_pk_bf16_f32 v82, v68, -v69
  v_cvt_pk_bf16_f32 v83, v70, -v71
  ds_write_b64 v84, v[82:83] offset:21648
  v_mul_f32 v76, v69, v49
  v_mul_f32 v77, v69, v48
  v_mul_f32 v78, v71, v51
  v_mul_f32 v79, v71, v50
  v_fma_f32 v73, v68, v49, v77
  v_fma_f32 v72, v68, v48, -v76
  v_fma_f32 v75, v70, v51, v79
  v_fma_f32 v74, v70, v50, -v78
  v_cvt_pk_bf16_f32 v80, v72, -v73
  v_cvt_pk_bf16_f32 v81, v74, -v75
  ds_write_b64 v84, v[80:81] offset:22176
  ds_write_b64 v84, v[80:81] offset:22704
  v_mul_f32 v76, v73, v49
  v_mul_f32 v77, v73, v48
  v_mul_f32 v78, v75, v51
  v_mul_f32 v79, v75, v50
  v_fma_f32 v69, v72, v49, v77
  v_fma_f32 v68, v72, v48, -v76
  v_fma_f32 v71, v74, v51, v79
  v_fma_f32 v70, v74, v50, -v78
  v_cvt_pk_bf16_f32 v82, v68, -v69
  v_cvt_pk_bf16_f32 v83, v70, -v71
  ds_write_b64 v84, v[82:83] offset:23232
  v_mul_f32 v76, v69, v49
  v_mul_f32 v77, v69, v48
  v_mul_f32 v78, v71, v51
  v_mul_f32 v79, v71, v50
  v_fma_f32 v73, v68, v49, v77
  v_fma_f32 v72, v68, v48, -v76
  v_fma_f32 v75, v70, v51, v79
  v_fma_f32 v74, v70, v50, -v78
  v_cvt_pk_bf16_f32 v80, v72, -v73
  v_cvt_pk_bf16_f32 v81, v74, -v75
  ds_write_b64 v84, v[80:81] offset:23760
  v_mul_f32 v76, v65, v61
  v_mul_f32 v77, v65, v60
  v_mul_f32 v78, v67, v63
  v_mul_f32 v79, v67, v62
  v_fma_f32 v65, v64, v61, v77
  v_fma_f32 v64, v64, v60, -v76
  v_fma_f32 v67, v66, v63, v79
  v_fma_f32 v66, v66, v62, -v78
  v_cvt_pk_bf16_f32 v82, v64, -v65
  v_cvt_pk_bf16_f32 v83, v66, -v67
  ds_write_b64 v84, v[82:83] offset:24288
  v_mul_f32 v76, v65, v53
  v_mul_f32 v77, v65, v52
  v_mul_f32 v78, v67, v55
  v_mul_f32 v79, v67, v54
  v_fma_f32 v69, v64, v53, v77
  v_fma_f32 v68, v64, v52, -v76
  v_fma_f32 v71, v66, v55, v79
  v_fma_f32 v70, v66, v54, -v78
  v_cvt_pk_bf16_f32 v80, v68, -v69
  v_cvt_pk_bf16_f32 v81, v70, -v71
  ds_write_b64 v84, v[80:81] offset:24816
  v_mul_f32 v76, v65, v57
  v_mul_f32 v77, v65, v56
  v_mul_f32 v78, v67, v59
  v_mul_f32 v79, v67, v58
  v_fma_f32 v73, v64, v57, v77
  v_fma_f32 v72, v64, v56, -v76
  v_fma_f32 v75, v66, v59, v79
  v_fma_f32 v74, v66, v58, -v78
  v_cvt_pk_bf16_f32 v82, v72, -v73
  v_cvt_pk_bf16_f32 v83, v74, -v75
  ds_write_b64 v84, v[82:83] offset:25344
  v_mul_f32 v76, v65, v61
  v_mul_f32 v77, v65, v60
  v_mul_f32 v78, v67, v63
  v_mul_f32 v79, v67, v62
  v_fma_f32 v65, v64, v61, v77
  v_fma_f32 v64, v64, v60, -v76
  v_fma_f32 v67, v66, v63, v79
  v_fma_f32 v66, v66, v62, -v78
  v_cvt_pk_bf16_f32 v80, v64, -v65
  v_cvt_pk_bf16_f32 v81, v66, -v67
  ds_write_b64 v84, v[80:81] offset:25872
  v_mul_f32 v76, v65, v53
  v_mul_f32 v77, v65, v52
  v_mul_f32 v78, v67, v55
  v_mul_f32 v79, v67, v54
  v_fma_f32 v69, v64, v53, v77
  v_fma_f32 v68, v64, v52, -v76
  v_fma_f32 v71, v66, v55, v79
  v_fma_f32 v70, v66, v54, -v78
  v_cvt_pk_bf16_f32 v82, v68, -v69
  v_cvt_pk_bf16_f32 v83, v70, -v71
  ds_write_b64 v84, v[82:83] offset:26400
  v_mul_f32 v76, v65, v57
  v_mul_f32 v77, v65, v56
  v_mul_f32 v78, v67, v59
  v_mul_f32 v79, v67, v58
  v_fma_f32 v73, v64, v57, v77
  v_fma_f32 v72, v64, v56, -v76
  v_fma_f32 v75, v66, v59, v79
  v_fma_f32 v74, v66, v58, -v78
  v_cvt_pk_bf16_f32 v80, v72, -v73
  v_cvt_pk_bf16_f32 v81, v74, -v75
  ds_write_b64 v84, v[80:81] offset:26928
  v_mul_f32 v76, v65, v61
  v_mul_f32 v77, v65, v60
  v_mul_f32 v78, v67, v63
  v_mul_f32 v79, v67, v62
  v_fma_f32 v65, v64, v61, v77
  v_fma_f32 v64, v64, v60, -v76
  v_fma_f32 v67, v66, v63, v79
  v_fma_f32 v66, v66, v62, -v78
  v_cvt_pk_bf16_f32 v82, v64, -v65
  v_cvt_pk_bf16_f32 v83, v66, -v67
  ds_write_b64 v84, v[82:83] offset:27456
  v_mul_f32 v76, v65, v57
  v_mul_f32 v77, v65, v56
  v_mul_f32 v78, v67, v59
  v_mul_f32 v79, v67, v58
  v_fma_f32 v69, v64, v57, v77
  v_fma_f32 v68, v64, v56, -v76
  v_fma_f32 v71, v66, v59, v79
  v_fma_f32 v70, v66, v58, -v78
  v_cvt_pk_bf16_f32 v80, v68, -v69
  v_cvt_pk_bf16_f32 v81, v70, -v71
  ds_write_b64 v84, v[80:81] offset:27984
  v_mul_f32 v76, v65, v61
  v_mul_f32 v77, v65, v60
  v_mul_f32 v78, v67, v63
  v_mul_f32 v79, v67, v62
  v_fma_f32 v65, v64, v61, v77
  v_fma_f32 v64, v64, v60, -v76
  v_fma_f32 v67, v66, v63, v79
  v_fma_f32 v66, v66, v62, -v78
  v_cvt_pk_bf16_f32 v82, v64, -v65
  v_cvt_pk_bf16_f32 v83, v66, -v67
  ds_write_b64 v84, v[82:83] offset:28512
  v_mul_f32 v76, v65, v57
  v_mul_f32 v77, v65, v56
  v_mul_f32 v78, v67, v59
  v_mul_f32 v79, v67, v58
  v_fma_f32 v69, v64, v57, v77
  v_fma_f32 v68, v64, v56, -v76
  v_fma_f32 v71, v66, v59, v79
  v_fma_f32 v70, v66, v58, -v78
  v_cvt_pk_bf16_f32 v80, v68, -v69
  v_cvt_pk_bf16_f32 v81, v70, -v71
  ds_write_b64 v84, v[80:81] offset:29040
  v_mul_f32 v76, v65, v61
  v_mul_f32 v77, v65, v60
  v_mul_f32 v78, v67, v63
  v_mul_f32 v79, v67, v62
  v_fma_f32 v65, v64, v61, v77
  v_fma_f32 v64, v64, v60, -v76
  v_fma_f32 v67, v66, v63, v79
  v_fma_f32 v66, v66, v62, -v78
  v_cvt_pk_bf16_f32 v82, v64, -v65
  v_cvt_pk_bf16_f32 v83, v66, -v67
  ds_write_b64 v84, v[82:83] offset:29568
  v_mul_f32 v76, v65, v57
  v_mul_f32 v77, v65, v56
  v_mul_f32 v78, v67, v59
  v_mul_f32 v79, v67, v58
  v_fma_f32 v69, v64, v57, v77
  v_fma_f32 v68, v64, v56, -v76
  v_fma_f32 v71, v66, v59, v79
  v_fma_f32 v70, v66, v58, -v78
  v_cvt_pk_bf16_f32 v80, v68, -v69
  v_cvt_pk_bf16_f32 v81, v70, -v71
  ds_write_b64 v84, v[80:81] offset:30096
  v_mul_f32 v76, v65, v61
  v_mul_f32 v77, v65, v60
  v_mul_f32 v78, v67, v63
  v_mul_f32 v79, v67, v62
  v_fma_f32 v65, v64, v61, v77
  v_fma_f32 v64, v64, v60, -v76
  v_fma_f32 v67, v66, v63, v79
  v_fma_f32 v66, v66, v62, -v78
  v_cvt_pk_bf16_f32 v82, v64, -v65
  v_cvt_pk_bf16_f32 v83, v66, -v67
  ds_write_b64 v84, v[82:83] offset:30624
  v_mul_f32 v76, v65, v57
  v_mul_f32 v77, v65, v56
  v_mul_f32 v78, v67, v59
  v_mul_f32 v79, v67, v58
  v_fma_f32 v69, v64, v57, v77
  v_fma_f32 v68, v64, v56, -v76
  v_fma_f32 v71, v66, v59, v79
  v_fma_f32 v70, v66, v58, -v78
  v_cvt_pk_bf16_f32 v80, v68, -v69
  v_cvt_pk_bf16_f32 v81, v70, -v71
  ds_write_b64 v84, v[80:81] offset:31152
L_gend_39:
  s_waitcnt lgkmcnt(0)
  s_barrier
  ds_read_b128 v[40:43], v87 offset:0
  ds_read_b128 v[44:47], v88 offset:0
  ds_read_b128 v[48:51], v89 offset:0
  ds_read_b128 v[52:55], v87 offset:64
  ds_read_b128 v[56:59], v88 offset:64
  ds_read_b128 v[60:63], v89 offset:64
  ds_read_b128 v[64:67], v87 offset:128
  ds_read_b128 v[68:71], v88 offset:128
  ds_read_b128 v[72:75], v89 offset:128
  s_waitcnt lgkmcnt(6)
  v_mfma_f32_16x16x32_bf16 v[108:111], v[40:43], v[48:51], 0
  v_mfma_f32_16x16x32_bf16 v[112:115], v[44:47], v[48:51], 0
  ds_read_b128 v[40:43], v87 offset:192
  ds_read_b128 v[44:47], v88 offset:192
  ds_read_b128 v[48:51], v89 offset:192
  s_waitcnt lgkmcnt(6)
  v_mfma_f32_16x16x32_bf16 v[108:111], v[52:55], v[60:63], v[108:111]
  v_mfma_f32_16x16x32_bf16 v[112:115], v[56:59], v[60:63], v[112:115]
  ds_read_b128 v[52:55], v87 offset:256
  ds_read_b128 v[56:59], v88 offset:256
  ds_read_b128 v[60:63], v89 offset:256
  s_waitcnt lgkmcnt(6)
  v_mfma_f32_16x16x32_bf16 v[108:111], v[64:67], v[72:75], v[108:111]
  v_mfma_f32_16x16x32_bf16 v[112:115], v[68:71], v[72:75], v[112:115]
  ds_read_b128 v[64:67], v87 offset:320
  ds_read_b128 v[68:71], v88 offset:320
  ds_read_b128 v[72:75], v89 offset:320
  s_waitcnt lgkmcnt(6)
  v_mfma_f32_16x16x32_bf16 v[108:111], v[40:43], v[48:51], v[108:111]
  v_mfma_f32_16x16x32_bf16 v[112:115], v[44:47], v[48:51], v[112:115]
  ds_read_b128 v[40:43], v87 offset:384
  ds_read_b128 v[44:47], v88 offset:384
  ds_read_b128 v[48:51], v89 offset:384
  s_waitcnt lgkmcnt(6)
  v_mfma_f32_16x16x32_bf16 v[108:111], v[52:55], v[60:63], v[108:111]
  v_mfma_f32_16x16x32_bf16 v[112:115], v[56:59], v[60:63], v[112:115]
  ds_read_b128 v[52:55], v87 offset:448
  ds_read_b128 v[56:59], v88 offset:448
  ds_read_b128 v[60:63], v89 offset:448
  s_waitcnt lgkmcnt(6)
  v_mfma_f32_16x16x32_bf16 v[108:111], v[64:67], v[72:75], v[108:111]
  v_mfma_f32_16x16x32_bf16 v[112:115], v[68:71], v[72:75], v[112:115]
  s_waitcnt lgkmcnt(3)
  v_mfma_f32_16x16x32_bf16 v[108:111], v[40:43], v[48:51], v[108:111]
  v_mfma_f32_16x16x32_bf16 v[112:115], v[44:47], v[48:51], v[112:115]
  s_waitcnt lgkmcnt(0)
  v_mfma_f32_16x16x32_bf16 v[108:111], v[52:55], v[60:63], v[108:111]
  v_mfma_f32_16x16x32_bf16 v[112:115], v[56:59], v[60:63], v[112:115]
  s_cmp_lg_u32 s25, 0
  s_cbranch_scc1 L_kta_40
  s_mul_i32 s3, s23, 4224
  v_lshlrev_b32 v28, 16, v27
  v_mov_b32 v36, 0
  v_mov_b32 v37, 0
  v_mov_b32 v38, 0
  v_mov_b32 v39, 0
  v_cndmask_b32 v28, 0, v28, s[40:41]
  buffer_store_dwordx4 v[36:39], v107, s[16:19], s3 offen
  s_nop 0
  v_add_f32 v108, v108, v28
  v_cvt_pk_bf16_f32 v29, v110, v111
  v_cvt_pk_bf16_f32 v28, v108, v109
  v_cvt_pk_bf16_f32 v30, v112, v113
  v_cvt_pk_bf16_f32 v31, v114, v115
  v_perm_b32 v32, v29, v28, v92
  v_perm_b32 v33, v29, v28, v93
  buffer_store_dwordx2 v[32:33], v104, s[16:19], s3 offen
  v_perm_b32 v116, v31, v30, v94
  v_perm_b32 v117, v31, v30, v92
  v_perm_b32 v118, v31, v30, v96
  v_perm_b32 v119, v31, v30, v97
  buffer_store_dwordx4 v[116:119], v105, s[16:19], s3 offen
  v_perm_b32 v120, v31, v30, v98
  v_perm_b32 v121, v31, v30, v98
  v_perm_b32 v122, v31, v30, v99
  v_perm_b32 v123, v31, v30, v100
  buffer_store_dwordx4 v[120:123], v106, s[16:19], s3 offen offset:512
  s_branch L_ktb_41
L_kta_40:
  s_mul_i32 s3, s23, 4224
  v_lshlrev_b32 v28, 16, v27
  v_mov_b32 v36, 0
  v_mov_b32 v37, 0
  v_mov_b32 v38, 0
  v_mov_b32 v39, 0
  v_cndmask_b32 v28, 0, v28, s[40:41]
  buffer_store_dwordx4 v[36:39], v107, s[16:19], s3 offen sc1
  s_nop 0
  v_add_f32 v108, v108, v28
  v_cvt_pk_bf16_f32 v29, v110, v111
  v_cvt_pk_bf16_f32 v28, v108, v109
  v_cvt_pk_bf16_f32 v30, v112, v113
  v_cvt_pk_bf16_f32 v31, v114, v115
  v_perm_b32 v32, v29, v28, v92
  v_perm_b32 v33, v29, v28, v93
  buffer_store_dwordx2 v[32:33], v104, s[16:19], s3 offen sc1
  v_perm_b32 v116, v31, v30, v94
  v_perm_b32 v117, v31, v30, v92
  v_perm_b32 v118, v31, v30, v96
  v_perm_b32 v119, v31, v30, v97
  buffer_store_dwordx4 v[116:119], v105, s[16:19], s3 offen sc1
  v_perm_b32 v120, v31, v30, v98
  v_perm_b32 v121, v31, v30, v98
  v_perm_b32 v122, v31, v30, v99
  v_perm_b32 v123, v31, v30, v100
  buffer_store_dwordx4 v[120:123], v106, s[16:19], s3 offen offset:512 sc1
L_ktb_41:
  s_cmp_eq_u32 s25, 0
  s_cbranch_scc1 L_kgd_37
  s_sub_u32 s30, s2, 384
  s_lshl_b32 s3, s30, 8
  s_add_u32 s3, s3, 13637888
  v_mov_b32 v5, s3
  v_mov_b32 v6, 1
  s_mov_b64 exec, 1
  s_waitcnt vmcnt(0)
  global_atomic_add v5, v6, s[12:13] sc1
  s_mov_b64 exec, -1
  s_mov_b32 s25, 0
  s_mov_b32 s23, s24
  s_barrier
  s_branch L_kgr_36
L_kgd_37:
  s_lshr_b32 s3, s20, 1
  s_mul_i32 s28, s3, 16640
  s_waitcnt vmcnt(0)
  s_barrier
  v_lshrrev_b32 v7, 2, v2
  v_lshlrev_b32 v7, 8, v7
  v_and_b32 v6, 3, v2
  v_lshl_add_u32 v7, v6, 4, v7
  s_lshl_b32 s30, s23, 12
  s_lshl_b32 s3, s33, 6
  s_add_u32 s30, s30, s3
  s_add_u32 s30, s30, 7471104
  buffer_load_dwordx4 v[12:15], v7, s[16:19], s30 offen sc1
  s_lshl_b32 s30, s23, 12
  s_lshl_b32 s3, s42, 6
  s_add_u32 s30, s30, s3
  s_add_u32 s30, s30, 7471104
  buffer_load_dwordx4 v[16:19], v7, s[16:19], s30 offen sc1
  s_mul_i32 s30, s23, 4224
  s_add_u32 s30, s30, 4980752
  s_lshl_b32 s3, s33, 1
  s_sub_u32 s30, s30, s3
  s_mul_i32 s31, s33, 4160
  s_add_u32 s31, s31, s28
  s_add_u32 m0, s31, 32
  s_mul_i32 s32, s33, 1152
  buffer_load_dwordx4 v4, s[16:19], s30 offen offset:0 sc1 lds
  buffer_load_dwordx4 v4, s[16:19], s30 offen offset:1024 sc1 lds
  buffer_load_dwordx4 v4, s[16:19], s30 offen offset:2048 sc1 lds
  buffer_load_dwordx4 v4, s[16:19], s30 offen offset:3072 sc1 lds
  v_add_u32 v5, s31, v4
  s_add_u32 s32, s32, s27
  s_sub_u32 s32, s32, 32
  v_add_u32 v6, s32, v4
  v_cmp_gt_u32 vcc, 2, v2
  s_mov_b64 s[34:35], exec
  s_nop 0
  v_cndmask_b32 v5, v6, v5, vcc
  s_mov_b64 exec, 0x3ff
  ds_write_b128 v5, v[8:11]
  s_mov_b64 exec, s[34:35]
  s_mul_i32 s30, s23, 4224
  s_add_u32 s30, s30, 4980752
  s_lshl_b32 s3, s42, 1
  s_sub_u32 s30, s30, s3
  s_mul_i32 s31, s42, 4160
  s_add_u32 s31, s31, s28
  s_add_u32 m0, s31, 32
  s_mul_i32 s32, s42, 1152
  buffer_load_dwordx4 v4, s[16:19], s30 offen offset:0 sc1 lds
  buffer_load_dwordx4 v4, s[16:19], s30 offen offset:1024 sc1 lds
  buffer_load_dwordx4 v4, s[16:19], s30 offen offset:2048 sc1 lds
  buffer_load_dwordx4 v4, s[16:19], s30 offen offset:3072 sc1 lds
  v_add_u32 v5, s31, v4
  s_add_u32 s32, s32, s27
  s_sub_u32 s32, s32, 32
  v_add_u32 v6, s32, v4
  v_cmp_gt_u32 vcc, 2, v2
  s_mov_b64 s[34:35], exec
  s_nop 0
  v_cndmask_b32 v5, v6, v5, vcc
  s_mov_b64 exec, 0x3ff
  ds_write_b128 v5, v[8:11]
  s_mov_b64 exec, s[34:35]
  s_waitcnt vmcnt(8)
  s_mul_i32 s32, s33, 1152
  s_add_u32 s32, s32, s27
  v_add_u32 v5, s32, v4
  ds_write_b128 v5, v[12:15] offset:128
  s_mul_i32 s32, s42, 1152
  s_add_u32 s32, s32, s27
  v_add_u32 v5, s32, v4
  ds_write_b128 v5, v[16:19] offset:128
  s_branch L_cvgo_22
L_cvx_21:
  s_setprio 3
  s_sub_u32 s36, s2, 336
  s_sub_u32 s3, s2, 368
  s_cmp_ge_u32 s2, 416
  s_cselect_b32 s36, s3, s36
  s_sub_u32 s3, s2, 384
  s_cmp_lt_u32 s3, 32
  s_cselect_b32 s36, -1, s36
  s_and_b32 s3, s36, 255
  s_mul_i32 s37, s3, 7282
  s_lshr_b32 s37, s37, 16
  s_mul_i32 s38, s37, 9
  s_sub_u32 s38, s3, s38
  v_and_b32 v103, 15, v2
  v_lshrrev_b32 v104, 4, v2
  s_cmp_ge_u32 s36, 144
  s_cbranch_scc1 L_not_42
  v_lshrrev_b32 v5, 3, v2
  v_and_b32 v6, 7, v2
  v_lshrrev_b32 v7, 2, v5
  v_lshlrev_b32 v7, 1, v7
  v_xor_b32 v6, v6, v7
  v_mul_u32_u24 v100, 1152, v5
  v_xor_b32 v7, 4, v6
  v_lshl_add_u32 v101, v7, 4, v100
  v_lshl_add_u32 v100, v6, 4, v100
  s_mul_i32 s3, s37, 147456
  s_lshl_b32 s30, s38, 7
  s_add_u32 s3, s3, s30
  s_add_u32 s30, s3, 0
  buffer_load_dwordx4 v[20:23], v100, s[8:11], s30 offen
  s_add_u32 s30, s3, 9216
  buffer_load_dwordx4 v[24:27], v101, s[8:11], s30 offen
  s_add_u32 s30, s3, 18432
  buffer_load_dwordx4 v[28:31], v100, s[8:11], s30 offen
  s_add_u32 s30, s3, 27648
  buffer_load_dwordx4 v[32:35], v101, s[8:11], s30 offen
  s_add_u32 s30, s3, 36864
  buffer_load_dwordx4 v[36:39], v100, s[8:11], s30 offen
  s_add_u32 s30, s3, 46080
  buffer_load_dwordx4 v[40:43], v101, s[8:11], s30 offen
  s_add_u32 s30, s3, 55296
  buffer_load_dwordx4 v[44:47], v100, s[8:11], s30 offen
  s_add_u32 s30, s3, 64512
  buffer_load_dwordx4 v[48:51], v101, s[8:11], s30 offen
  s_add_u32 s30, s3, 73728
  buffer_load_dwordx4 v[52:55], v100, s[8:11], s30 offen
  s_add_u32 s30, s3, 82944
  buffer_load_dwordx4 v[56:59], v101, s[8:11], s30 offen
  s_add_u32 s30, s3, 92160
  buffer_load_dwordx4 v[60:63], v100, s[8:11], s30 offen
  s_add_u32 s30, s3, 101376
  buffer_load_dwordx4 v[64:67], v101, s[8:11], s30 offen
  s_add_u32 s30, s3, 110592
  buffer_load_dwordx4 v[68:71], v100, s[8:11], s30 offen
  s_add_u32 s30, s3, 119808
  buffer_load_dwordx4 v[72:75], v101, s[8:11], s30 offen
  s_add_u32 s30, s3, 129024
  buffer_load_dwordx4 v[76:79], v100, s[8:11], s30 offen
  s_add_u32 s30, s3, 138240
  buffer_load_dwordx4 v[80:83], v101, s[8:11], s30 offen
  v_mov_b32 v100, 0
  global_load_dword v101, v100, s[14:15]
  v_lshrrev_b32 v5, 2, v103
  v_lshlrev_b32 v102, 9, v5
  v_lshl_add_u32 v102, v104, 7, v102
  v_lshl_add_u32 v102, v5, 5, v102
  v_and_b32 v6, 3, v2
  v_lshl_add_u32 v102, v6, 3, v102
  v_mul_u32_u24 v16, 80, v2
  v_lshl_add_u32 v7, v5, 4, v104
  v_mul_u32_u24 v17, 80, v7
  v_lshl_add_u32 v17, v6, 4, v17
  v_lshlrev_b32 v18, 12, v104
  v_lshl_add_u32 v18, v103, 4, v18
  v_xor_b32 v12, 0, v102
  v_add_u32 v12, 63488, v12
  v_xor_b32 v13, 32, v102
  v_add_u32 v13, 63488, v13
  v_xor_b32 v14, 64, v102
  v_add_u32 v14, 63488, v14
  v_xor_b32 v15, 96, v102
  v_add_u32 v15, 63488, v15
  v_add_u32 v19, 63488, v4
  v_add_u32 v16, 71680, v16
  v_add_u32 v17, 71680, v17
  s_waitcnt vmcnt(9)
  ds_write_b128 v19, v[20:23] offset:0
  ds_write_b128 v19, v[24:27] offset:1024
  ds_write_b128 v19, v[28:31] offset:2048
  ds_write_b128 v19, v[32:35] offset:3072
  ds_write_b128 v19, v[36:39] offset:4096
  ds_write_b128 v19, v[40:43] offset:5120
  ds_write_b128 v19, v[44:47] offset:6144
  ds_write_b128 v19, v[48:51] offset:7168
  s_waitcnt lgkmcnt(0)
  ds_read_b64_tr_b16 v[20:21], v12 offset:0
  ds_read_b64_tr_b16 v[22:23], v12 offset:2048
  ds_read_b64_tr_b16 v[24:25], v12 offset:4096
  ds_read_b64_tr_b16 v[26:27], v12 offset:6144
  ds_read_b64_tr_b16 v[28:29], v13 offset:0
  ds_read_b64_tr_b16 v[30:31], v13 offset:2048
  ds_read_b64_tr_b16 v[32:33], v13 offset:4096
  ds_read_b64_tr_b16 v[34:35], v13 offset:6144
  s_waitcnt lgkmcnt(0)
  ds_read_b64_tr_b16 v[36:37], v14 offset:0
  ds_read_b64_tr_b16 v[38:39], v14 offset:2048
  ds_read_b64_tr_b16 v[40:41], v14 offset:4096
  ds_read_b64_tr_b16 v[42:43], v14 offset:6144
  ds_read_b64_tr_b16 v[44:45], v15 offset:0
  ds_read_b64_tr_b16 v[46:47], v15 offset:2048
  ds_read_b64_tr_b16 v[48:49], v15 offset:4096
  ds_read_b64_tr_b16 v[50:51], v15 offset:6144
  s_waitcnt lgkmcnt(0)
  s_waitcnt vmcnt(0)
  ds_write_b128 v19, v[52:55] offset:0
  ds_write_b128 v19, v[56:59] offset:1024
  ds_write_b128 v19, v[60:63] offset:2048
  ds_write_b128 v19, v[64:67] offset:3072
  ds_write_b128 v19, v[68:71] offset:4096
  ds_write_b128 v19, v[72:75] offset:5120
  ds_write_b128 v19, v[76:79] offset:6144
  ds_write_b128 v19, v[80:83] offset:7168
  s_waitcnt lgkmcnt(0)
  ds_read_b64_tr_b16 v[52:53], v12 offset:0
  ds_read_b64_tr_b16 v[54:55], v12 offset:2048
  ds_read_b64_tr_b16 v[56:57], v12 offset:4096
  ds_read_b64_tr_b16 v[58:59], v12 offset:6144
  ds_read_b64_tr_b16 v[60:61], v13 offset:0
  ds_read_b64_tr_b16 v[62:63], v13 offset:2048
  ds_read_b64_tr_b16 v[64:65], v13 offset:4096
  ds_read_b64_tr_b16 v[66:67], v13 offset:6144
  s_waitcnt lgkmcnt(0)
  ds_read_b64_tr_b16 v[68:69], v14 offset:0
  ds_read_b64_tr_b16 v[70:71], v14 offset:2048
  ds_read_b64_tr_b16 v[72:73], v14 offset:4096
  ds_read_b64_tr_b16 v[74:75], v14 offset:6144
  ds_read_b64_tr_b16 v[76:77], v15 offset:0
  ds_read_b64_tr_b16 v[78:79], v15 offset:2048
  ds_read_b64_tr_b16 v[80:81], v15 offset:4096
  ds_read_b64_tr_b16 v[82:83], v15 offset:6144
  s_waitcnt lgkmcnt(0)
  v_readfirstlane_b32 s3, v101
  s_nop 3
  s_cmp_lg_u32 s3, 0
  s_cbranch_scc1 L_rk_43
  v_mov_b32 v5, 0
  global_load_dword v6, v5, s[14:15]
  s_waitcnt vmcnt(0)
  v_readfirstlane_b32 s31, v6
  s_nop 3
  s_cmp_lg_u32 s31, 0
  s_cbranch_scc1 L_rdy_44
  s_sleep 12
  s_mov_b32 s31, 0x10000
L_pl_45:
  global_load_dword v6, v5, s[14:15] sc1
  s_waitcnt vmcnt(0)
  v_cmp_eq_u32 vcc, 0, v6
  s_sub_u32 s31, s31, 1
  s_cbranch_scc1 L_pd_46
  s_nop 2
  s_cmp_eq_u64 vcc, 0
  s_cbranch_scc1 L_pd_46
  s_sleep 12
  s_branch L_pl_45
L_pd_46:
L_rdy_44:
L_rk_43:
  s_lshl_b32 s3, s38, 18
  s_lshl_b32 s30, s37, 8
  s_add_u32 s3, s3, s30
  s_add_u32 s3, s3, 7471104
  ds_write_b128 v16, v[20:23] offset:0
  ds_write_b128 v16, v[24:27] offset:16
  ds_write_b128 v16, v[52:55] offset:32
  ds_write_b128 v16, v[56:59] offset:48
  s_waitcnt lgkmcnt(0)
  ds_read_b128 v[84:87], v17 offset:0
  ds_read_b128 v[88:91], v17 offset:320
  ds_read_b128 v[92:95], v17 offset:640
  ds_read_b128 v[96:99], v17 offset:960
  s_add_u32 s30, s3, 0
  s_waitcnt lgkmcnt(3)
  buffer_store_dwordx4 v[84:87], v18, s[16:19], s30 offen sc1
  s_add_u32 s30, s3, 16384
  s_waitcnt lgkmcnt(2)
  buffer_store_dwordx4 v[88:91], v18, s[16:19], s30 offen sc1
  s_add_u32 s30, s3, 32768
  s_waitcnt lgkmcnt(1)
  buffer_store_dwordx4 v[92:95], v18, s[16:19], s30 offen sc1
  s_add_u32 s30, s3, 49152
  s_waitcnt lgkmcnt(0)
  buffer_store_dwordx4 v[96:99], v18, s[16:19], s30 offen sc1
  ds_write_b128 v16, v[28:31] offset:0
  ds_write_b128 v16, v[32:35] offset:16
  ds_write_b128 v16, v[60:63] offset:32
  ds_write_b128 v16, v[64:67] offset:48
  s_waitcnt lgkmcnt(0)
  ds_read_b128 v[84:87], v17 offset:0
  ds_read_b128 v[88:91], v17 offset:320
  ds_read_b128 v[92:95], v17 offset:640
  ds_read_b128 v[96:99], v17 offset:960
  s_add_u32 s30, s3, 65536
  s_waitcnt lgkmcnt(3)
  buffer_store_dwordx4 v[84:87], v18, s[16:19], s30 offen sc1
  s_add_u32 s30, s3, 81920
  s_waitcnt lgkmcnt(2)
  buffer_store_dwordx4 v[88:91], v18, s[16:19], s30 offen sc1
  s_add_u32 s30, s3, 98304
  s_waitcnt lgkmcnt(1)
  buffer_store_dwordx4 v[92:95], v18, s[16:19], s30 offen sc1
  s_add_u32 s30, s3, 114688
  s_waitcnt lgkmcnt(0)
  buffer_store_dwordx4 v[96:99], v18, s[16:19], s30 offen sc1
  ds_write_b128 v16, v[36:39] offset:0
  ds_write_b128 v16, v[40:43] offset:16
  ds_write_b128 v16, v[68:71] offset:32
  ds_write_b128 v16, v[72:75] offset:48
  s_waitcnt lgkmcnt(0)
  ds_read_b128 v[84:87], v17 offset:0
  ds_read_b128 v[88:91], v17 offset:320
  ds_read_b128 v[92:95], v17 offset:640
  ds_read_b128 v[96:99], v17 offset:960
  s_add_u32 s30, s3, 131072
  s_waitcnt lgkmcnt(3)
  buffer_store_dwordx4 v[84:87], v18, s[16:19], s30 offen sc1
  s_add_u32 s30, s3, 147456
  s_waitcnt lgkmcnt(2)
  buffer_store_dwordx4 v[88:91], v18, s[16:19], s30 offen sc1
  s_add_u32 s30, s3, 163840
  s_waitcnt lgkmcnt(1)
  buffer_store_dwordx4 v[92:95], v18, s[16:19], s30 offen sc1
  s_add_u32 s30, s3, 180224
  s_waitcnt lgkmcnt(0)
  buffer_store_dwordx4 v[96:99], v18, s[16:19], s30 offen sc1
  ds_write_b128 v16, v[44:47] offset:0
  ds_write_b128 v16, v[48:51] offset:16
  ds_write_b128 v16, v[76:79] offset:32
  ds_write_b128 v16, v[80:83] offset:48
  s_waitcnt lgkmcnt(0)
  ds_read_b128 v[84:87], v17 offset:0
  ds_read_b128 v[88:91], v17 offset:320
  ds_read_b128 v[92:95], v17 offset:640
  ds_read_b128 v[96:99], v17 offset:960
  s_add_u32 s30, s3, 196608
  s_waitcnt lgkmcnt(3)
  buffer_store_dwordx4 v[84:87], v18, s[16:19], s30 offen sc1
  s_add_u32 s30, s3, 212992
  s_waitcnt lgkmcnt(2)
  buffer_store_dwordx4 v[88:91], v18, s[16:19], s30 offen sc1
  s_add_u32 s30, s3, 229376
  s_waitcnt lgkmcnt(1)
  buffer_store_dwordx4 v[92:95], v18, s[16:19], s30 offen sc1
  s_add_u32 s30, s3, 245760
  s_waitcnt lgkmcnt(0)
  buffer_store_dwordx4 v[96:99], v18, s[16:19], s30 offen sc1
  s_lshl_b32 s32, s38, 8
  s_add_u32 s32, s32, 13631488
  s_waitcnt vmcnt(0)
  v_mov_b32 v5, s32
  v_mov_b32 v6, 1
  s_mov_b64 exec, 1
  global_atomic_add v7, v5, v6, s[12:13] sc0 sc1
  s_mov_b64 exec, -1
  s_lshl_b32 s32, s38, 11
  s_add_u32 s32, s32, 13646080
  v_lshlrev_b32 v5, 8, v2
  v_add_u32 v5, s32, v5
  s_waitcnt vmcnt(0)
  v_readfirstlane_b32 s3, v7
  s_nop 3
  s_cmp_lg_u32 s3, 15
  s_cbranch_scc1 L_nl_47
  s_mov_b64 exec, 0xff
  global_store_dword v5, v6, s[12:13] sc1
  s_mov_b64 exec, -1
L_nl_47:
  s_mov_b32 s39, 0
  s_branch L_tdone
L_not_42:
  s_mov_b32 s39, 0
  v_mov_b32 v5, 0
  global_load_dword v6, v5, s[14:15]
  s_waitcnt vmcnt(0)
  v_readfirstlane_b32 s31, v6
  s_nop 3
  s_cmp_lg_u32 s31, 0
  s_cbranch_scc1 L_rdy_48
  s_sleep 12
  s_mov_b32 s31, 0x10000
L_pl_49:
  global_load_dword v6, v5, s[14:15] sc1
  s_waitcnt vmcnt(0)
  v_cmp_eq_u32 vcc, 0, v6
  s_sub_u32 s31, s31, 1
  s_cbranch_scc1 L_pd_50
  s_nop 2
  s_cmp_eq_u64 vcc, 0
  s_cbranch_scc1 L_pd_50
  s_sleep 12
  s_branch L_pl_49
L_pd_50:
L_rdy_48:
L_tdone:
  s_sub_u32 s30, s2, 384
  s_cmp_ge_u32 s30, 32
  s_cbranch_scc1 L_nx_51
  s_barrier
  s_barrier
L_nx_51:
  s_lshr_b32 s23, s22, 2
  s_add_u32 s23, s23, s21
  s_add_u32 s23, s23, 64
  s_mov_b32 s28, 33280
  s_mov_b32 s27, 49920
  s_mov_b32 s44, 0
  s_mov_b32 s45, 1
  s_mov_b32 s46, 2
  s_mov_b32 s47, 3
  s_setprio 0
  s_barrier
  s_and_b32 s48, s22, 7
  s_lshl_b32 s48, s48, 8
  s_add_u32 s48, s48, 13646080
  s_lshr_b32 s32, s23, 6
  s_lshl_b32 s32, s32, 11
  s_add_u32 s32, s32, s48
  v_mov_b32 v5, s32
  s_lshl_b32 s32, s22, 1
  s_add_u32 s32, s32, s21
  s_lshr_b32 s32, s32, 6
  s_lshl_b32 s32, s32, 11
  s_add_u32 s32, s32, s48
  v_writelane_b32 v5, s32, 1
  s_and_b32 s32, s2, 7
  s_lshl_b32 s32, s32, 2
  s_lshr_b32 s3, s22, 3
  s_add_u32 s32, s32, s3
  s_lshl_b32 s32, s32, 8
  s_add_u32 s32, s32, 13637888
  v_writelane_b32 v5, s32, 2
  v_mov_b32 v7, 1
  v_writelane_b32 v7, 4, 2
  s_mov_b64 exec, 2
  s_mov_b32 s31, 0x10000
L_pl_52:
  global_load_dword v6, v5, s[12:13] sc1
  s_waitcnt vmcnt(0)
  v_cmp_gt_u32 vcc, v7, v6
  s_sub_u32 s31, s31, 1
  s_cbranch_scc1 L_pd_53
  s_nop 2
  s_cmp_eq_u64 vcc, 0
  s_cbranch_scc1 L_pd_53
  s_sleep 12
  s_branch L_pl_52
L_pd_53:
  s_barrier
  s_barrier
  s_mov_b64 exec, 5
  s_mov_b32 s31, 0x10000
L_pl_54:
  global_load_dword v6, v5, s[12:13] sc1
  s_waitcnt vmcnt(0)
  v_cmp_gt_u32 vcc, v7, v6
  s_sub_u32 s31, s31, 1
  s_cbranch_scc1 L_pd_55
  s_nop 2
  s_cmp_eq_u64 vcc, 0
  s_cbranch_scc1 L_pd_55
  s_sleep 12
  s_branch L_pl_54
L_pd_55:
  s_mov_b64 exec, -1
  v_lshrrev_b32 v7, 2, v2
  v_lshlrev_b32 v7, 8, v7
  v_and_b32 v6, 3, v2
  v_lshl_add_u32 v7, v6, 4, v7
  s_lshl_b32 s30, s23, 12
  s_lshl_b32 s3, s44, 6
  s_add_u32 s30, s30, s3
  s_add_u32 s30, s30, 7471104
  buffer_load_dwordx4 v[20:23], v7, s[16:19], s30 offen sc1
  s_lshl_b32 s30, s23, 12
  s_lshl_b32 s3, s45, 6
  s_add_u32 s30, s30, s3
  s_add_u32 s30, s30, 7471104
  buffer_load_dwordx4 v[24:27], v7, s[16:19], s30 offen sc1
  s_lshl_b32 s30, s23, 12
  s_lshl_b32 s3, s46, 6
  s_add_u32 s30, s30, s3
  s_add_u32 s30, s30, 7471104
  buffer_load_dwordx4 v[28:31], v7, s[16:19], s30 offen sc1
  s_lshl_b32 s30, s23, 12
  s_lshl_b32 s3, s47, 6
  s_add_u32 s30, s30, s3
  s_add_u32 s30, s30, 7471104
  buffer_load_dwordx4 v[32:35], v7, s[16:19], s30 offen sc1
  s_mul_i32 s30, s23, 4224
  s_add_u32 s30, s30, 4980752
  s_lshl_b32 s3, s44, 1
  s_sub_u32 s30, s30, s3
  s_mul_i32 s31, s44, 4160
  s_add_u32 s31, s31, s28
  s_add_u32 m0, s31, 32
  s_mul_i32 s32, s44, 1152
  buffer_load_dwordx4 v4, s[16:19], s30 offen offset:0 sc1 lds
  buffer_load_dwordx4 v4, s[16:19], s30 offen offset:1024 sc1 lds
  buffer_load_dwordx4 v4, s[16:19], s30 offen offset:2048 sc1 lds
  buffer_load_dwordx4 v4, s[16:19], s30 offen offset:3072 sc1 lds
  v_add_u32 v5, s31, v4
  s_add_u32 s32, s32, s27
  s_sub_u32 s32, s32, 32
  v_add_u32 v6, s32, v4
  v_cmp_gt_u32 vcc, 2, v2
  s_mov_b64 s[34:35], exec
  s_nop 0
  v_cndmask_b32 v5, v6, v5, vcc
  s_mov_b64 exec, 0x3ff
  ds_write_b128 v5, v[8:11]
  s_mov_b64 exec, s[34:35]
  s_mul_i32 s30, s23, 4224
  s_add_u32 s30, s30, 4980752
  s_lshl_b32 s3, s45, 1
  s_sub_u32 s30, s30, s3
  s_mul_i32 s31, s45, 4160
  s_add_u32 s31, s31, s28
  s_add_u32 m0, s31, 32
  s_mul_i32 s32, s45, 1152
  buffer_load_dwordx4 v4, s[16:19], s30 offen offset:0 sc1 lds
  buffer_load_dwordx4 v4, s[16:19], s30 offen offset:1024 sc1 lds
  buffer_load_dwordx4 v4, s[16:19], s30 offen offset:2048 sc1 lds
  buffer_load_dwordx4 v4, s[16:19], s30 offen offset:3072 sc1 lds
  v_add_u32 v5, s31, v4
  s_add_u32 s32, s32, s27
  s_sub_u32 s32, s32, 32
  v_add_u32 v6, s32, v4
  v_cmp_gt_u32 vcc, 2, v2
  s_mov_b64 s[34:35], exec
  s_nop 0
  v_cndmask_b32 v5, v6, v5, vcc
  s_mov_b64 exec, 0x3ff
  ds_write_b128 v5, v[8:11]
  s_mov_b64 exec, s[34:35]
  s_mul_i32 s30, s23, 4224
  s_add_u32 s30, s30, 4980752
  s_lshl_b32 s3, s46, 1
  s_sub_u32 s30, s30, s3
  s_mul_i32 s31, s46, 4160
  s_add_u32 s31, s31, s28
  s_add_u32 m0, s31, 32
  s_mul_i32 s32, s46, 1152
  buffer_load_dwordx4 v4, s[16:19], s30 offen offset:0 sc1 lds
  buffer_load_dwordx4 v4, s[16:19], s30 offen offset:1024 sc1 lds
  buffer_load_dwordx4 v4, s[16:19], s30 offen offset:2048 sc1 lds
  buffer_load_dwordx4 v4, s[16:19], s30 offen offset:3072 sc1 lds
  v_add_u32 v5, s31, v4
  s_add_u32 s32, s32, s27
  s_sub_u32 s32, s32, 32
  v_add_u32 v6, s32, v4
  v_cmp_gt_u32 vcc, 2, v2
  s_mov_b64 s[34:35], exec
  s_nop 0
  v_cndmask_b32 v5, v6, v5, vcc
  s_mov_b64 exec, 0x3ff
  ds_write_b128 v5, v[8:11]
  s_mov_b64 exec, s[34:35]
  s_mul_i32 s30, s23, 4224
  s_add_u32 s30, s30, 4980752
  s_lshl_b32 s3, s47, 1
  s_sub_u32 s30, s30, s3
  s_mul_i32 s31, s47, 4160
  s_add_u32 s31, s31, s28
  s_add_u32 m0, s31, 32
  s_mul_i32 s32, s47, 1152
  buffer_load_dwordx4 v4, s[16:19], s30 offen offset:0 sc1 lds
  buffer_load_dwordx4 v4, s[16:19], s30 offen offset:1024 sc1 lds
  buffer_load_dwordx4 v4, s[16:19], s30 offen offset:2048 sc1 lds
  buffer_load_dwordx4 v4, s[16:19], s30 offen offset:3072 sc1 lds
  v_add_u32 v5, s31, v4
  s_add_u32 s32, s32, s27
  s_sub_u32 s32, s32, 32
  v_add_u32 v6, s32, v4
  v_cmp_gt_u32 vcc, 2, v2
  s_mov_b64 s[34:35], exec
  s_nop 0
  v_cndmask_b32 v5, v6, v5, vcc
  s_mov_b64 exec, 0x3ff
  ds_write_b128 v5, v[8:11]
  s_mov_b64 exec, s[34:35]
  s_waitcnt vmcnt(16)
  s_mul_i32 s32, s44, 1152
  s_add_u32 s32, s32, s27
  v_add_u32 v5, s32, v4
  ds_write_b128 v5, v[20:23] offset:128
  s_mul_i32 s32, s45, 1152
  s_add_u32 s32, s32, s27
  v_add_u32 v5, s32, v4
  ds_write_b128 v5, v[24:27] offset:128
  s_mul_i32 s32, s46, 1152
  s_add_u32 s32, s32, s27
  v_add_u32 v5, s32, v4
  ds_write_b128 v5, v[28:31] offset:128
  s_mul_i32 s32, s47, 1152
  s_add_u32 s32, s32, s27
  v_add_u32 v5, s32, v4
  ds_write_b128 v5, v[32:35] offset:128
L_cvgo_22:
  v_and_b32 v103, 15, v2
  v_lshrrev_b32 v104, 4, v2
  v_mul_u32_u24 v100, 4160, v104
  v_lshrrev_b32 v5, 2, v103
  v_and_b32 v6, 3, v2
  v_sub_u32 v6, v6, v5
  v_lshl_add_u32 v100, v6, 3, v100
  s_add_u32 s3, s28, 32
  v_add_u32 v100, s3, v100
  v_mul_u32_u24 v101, 1152, v104
  v_lshl_add_u32 v101, v103, 3, v101
  s_add_u32 s3, s27, 120
  v_add_u32 v101, s3, v101
  s_lshl_b32 s3, s23, 12
  s_add_u32 s3, s3, 10485760
  v_add_u32 v102, s3, v4
  v_mov_b32 v84, 0
  v_mov_b32 v85, 0
  v_mov_b32 v86, 0
  v_mov_b32 v87, 0
  v_mov_b32 v88, 0
  v_mov_b32 v89, 0
  v_mov_b32 v90, 0
  v_mov_b32 v91, 0
  v_mov_b32 v92, 0
  v_mov_b32 v93, 0
  v_mov_b32 v94, 0
  v_mov_b32 v95, 0
  v_mov_b32 v96, 0
  v_mov_b32 v97, 0
  v_mov_b32 v98, 0
  v_mov_b32 v99, 0
  s_mov_b32 s29, 0
  s_waitcnt vmcnt(0) lgkmcnt(0)
  s_setprio 1
  s_cmp_eq_u32 s20, 4
  s_cbranch_scc1 L_nb3_56
  s_barrier
  s_setprio 0
L_nb3_56:
  s_cmp_eq_u32 s20, 4
  s_cbranch_scc1 L_cvq_63
  s_bitcmp1_b32 s20, 0
  s_cbranch_scc1 L_cvset_58
  s_branch L_cvset_57
L_cvq_63:
  s_and_b32 s3, s22, 3
  s_cmp_eq_u32 s3, 1
  s_cbranch_scc1 L_cvset_60
  s_cmp_eq_u32 s3, 2
  s_cbranch_scc1 L_cvset_61
  s_cmp_eq_u32 s3, 3
  s_cbranch_scc1 L_cvset_62
  s_branch L_cvset_59
L_cvset_57:
  ds_read_b64_tr_b16 v[20:21], v100 offset:32
  ds_read_b64_tr_b16 v[22:23], v100 offset:0
  ds_read_b64 v[52:53], v101 offset:0
  ds_read_b64 v[54:55], v101 offset:8
  ds_read_b64_tr_b16 v[24:25], v100 offset:544
  ds_read_b64_tr_b16 v[26:27], v100 offset:512
  ds_read_b64 v[56:57], v101 offset:128
  ds_read_b64 v[58:59], v101 offset:136
L_cvloop_64:
  ds_read_b64_tr_b16 v[40:41], v100 offset:2592
  ds_read_b64_tr_b16 v[42:43], v100 offset:2560
  ds_read_b64 v[72:73], v101 offset:640
  ds_read_b64 v[74:75], v101 offset:648
  s_waitcnt lgkmcnt(8)
  v_mfma_f32_16x16x32_bf16 v[84:87], v[20:23], v[52:55], v[84:87]
  ds_read_b64_tr_b16 v[28:29], v100 offset:1056
  ds_read_b64_tr_b16 v[30:31], v100 offset:1024
  ds_read_b64 v[60:61], v101 offset:256
  ds_read_b64 v[62:63], v101 offset:264
  s_waitcnt lgkmcnt(8)
  v_mfma_f32_16x16x32_bf16 v[88:91], v[20:23], v[56:59], v[88:91]
  v_mfma_f32_16x16x32_bf16 v[88:91], v[24:27], v[52:55], v[88:91]
  ds_read_b64_tr_b16 v[44:45], v100 offset:3104
  ds_read_b64_tr_b16 v[46:47], v100 offset:3072
  ds_read_b64 v[76:77], v101 offset:768
  ds_read_b64 v[78:79], v101 offset:776
  s_waitcnt lgkmcnt(8)
  v_mfma_f32_16x16x32_bf16 v[92:95], v[24:27], v[72:75], v[92:95]
  v_mfma_f32_16x16x32_bf16 v[92:95], v[40:43], v[56:59], v[92:95]
  ds_read_b64_tr_b16 v[48:49], v100 offset:3616
  ds_read_b64_tr_b16 v[50:51], v100 offset:3584
  ds_read_b64 v[80:81], v101 offset:896
  ds_read_b64 v[82:83], v101 offset:904
  s_waitcnt lgkmcnt(8)
  v_mfma_f32_16x16x32_bf16 v[96:99], v[28:31], v[72:75], v[96:99]
  v_mfma_f32_16x16x32_bf16 v[96:99], v[40:43], v[60:63], v[96:99]
  ds_read_b64_tr_b16 v[36:37], v100 offset:2080
  ds_read_b64_tr_b16 v[38:39], v100 offset:2048
  ds_read_b64 v[68:69], v101 offset:512
  ds_read_b64 v[70:71], v101 offset:520
  s_waitcnt lgkmcnt(8)
  v_mfma_f32_16x16x32_bf16 v[92:95], v[20:23], v[76:79], v[92:95]
  v_mfma_f32_16x16x32_bf16 v[92:95], v[44:47], v[52:55], v[92:95]
  v_mfma_f32_16x16x32_bf16 v[96:99], v[24:27], v[76:79], v[96:99]
  v_mfma_f32_16x16x32_bf16 v[96:99], v[44:47], v[56:59], v[96:99]
  ds_read_b64_tr_b16 v[32:33], v100 offset:1568
  ds_read_b64_tr_b16 v[34:35], v100 offset:1536
  ds_read_b64 v[64:65], v101 offset:384
  ds_read_b64 v[66:67], v101 offset:392
  s_waitcnt lgkmcnt(8)
  v_mfma_f32_16x16x32_bf16 v[96:99], v[20:23], v[80:83], v[96:99]
  v_mfma_f32_16x16x32_bf16 v[96:99], v[48:51], v[52:55], v[96:99]
  v_add_u32 v100, 64, v100
  v_subrev_u32 v101, 16, v101
  ds_read_b64_tr_b16 v[20:21], v100 offset:32
  ds_read_b64_tr_b16 v[22:23], v100 offset:0
  ds_read_b64 v[52:53], v101 offset:0
  ds_read_b64 v[54:55], v101 offset:8
  s_waitcnt lgkmcnt(8)
  v_mfma_f32_16x16x32_bf16 v[92:95], v[28:31], v[68:71], v[92:95]
  v_mfma_f32_16x16x32_bf16 v[92:95], v[36:39], v[60:63], v[92:95]
  ds_read_b64_tr_b16 v[24:25], v100 offset:544
  ds_read_b64_tr_b16 v[26:27], v100 offset:512
  ds_read_b64 v[56:57], v101 offset:128
  ds_read_b64 v[58:59], v101 offset:136
  s_waitcnt lgkmcnt(8)
  v_mfma_f32_16x16x32_bf16 v[92:95], v[32:35], v[64:67], v[92:95]
  v_mfma_f32_16x16x32_bf16 v[96:99], v[32:35], v[68:71], v[96:99]
  v_mfma_f32_16x16x32_bf16 v[96:99], v[36:39], v[64:67], v[96:99]
  s_add_u32 s29, s29, 1
  s_cmp_lt_u32 s29, 8
  s_cbranch_scc1 L_cvloop_64
  s_waitcnt lgkmcnt(0)
  s_nop 7
  v_cvt_pk_bf16_f32 v20, v84, v85
  v_cvt_pk_bf16_f32 v21, v86, v87
  v_cvt_pk_bf16_f32 v22, v88, v89
  v_cvt_pk_bf16_f32 v23, v90, v91
  v_cvt_pk_bf16_f32 v24, v92, v93
  v_cvt_pk_bf16_f32 v25, v94, v95
  v_cvt_pk_bf16_f32 v26, v96, v97
  v_cvt_pk_bf16_f32 v27, v98, v99
  s_lshr_b32 s32, s23, 3
  s_lshl_b32 s32, s32, 7
  s_and_b32 s3, s23, 7
  s_lshl_b32 s3, s3, 2
  s_add_u32 s32, s32, s3
  s_add_u32 s32, s32, 14218240
  v_mov_b32 v5, s32
  v_mov_b32 v6, 0x0101
  buffer_store_dwordx4 v[20:23], v102, s[16:19], 0 offen offset:0 sc1
  buffer_store_dwordx4 v[24:27], v102, s[16:19], 0 offen offset:3072 sc1
  s_mov_b64 exec, 1
  s_waitcnt vmcnt(0)
  global_store_short v5, v6, s[12:13] offset:0 sc1
  s_mov_b64 exec, -1
  s_branch L_phaseY4
L_cvset_58:
  ds_read_b64_tr_b16 v[28:29], v100 offset:1056
  ds_read_b64_tr_b16 v[30:31], v100 offset:1024
  ds_read_b64 v[60:61], v101 offset:256
  ds_read_b64 v[62:63], v101 offset:264
  ds_read_b64_tr_b16 v[24:25], v100 offset:544
  ds_read_b64_tr_b16 v[26:27], v100 offset:512
  ds_read_b64 v[56:57], v101 offset:128
  ds_read_b64 v[58:59], v101 offset:136
L_cvloop_65:
  ds_read_b64_tr_b16 v[32:33], v100 offset:1568
  ds_read_b64_tr_b16 v[34:35], v100 offset:1536
  ds_read_b64 v[64:65], v101 offset:384
  ds_read_b64 v[66:67], v101 offset:392
  s_waitcnt lgkmcnt(8)
  v_mfma_f32_16x16x32_bf16 v[92:95], v[28:31], v[60:63], v[92:95]
  ds_read_b64_tr_b16 v[20:21], v100 offset:32
  ds_read_b64_tr_b16 v[22:23], v100 offset:0
  ds_read_b64 v[52:53], v101 offset:0
  ds_read_b64 v[54:55], v101 offset:8
  s_waitcnt lgkmcnt(8)
  v_mfma_f32_16x16x32_bf16 v[84:87], v[24:27], v[56:59], v[84:87]
  v_mfma_f32_16x16x32_bf16 v[88:91], v[24:27], v[60:63], v[88:91]
  v_mfma_f32_16x16x32_bf16 v[88:91], v[28:31], v[56:59], v[88:91]
  ds_read_b64_tr_b16 v[36:37], v100 offset:2080
  ds_read_b64_tr_b16 v[38:39], v100 offset:2048
  ds_read_b64 v[68:69], v101 offset:512
  ds_read_b64 v[70:71], v101 offset:520
  s_waitcnt lgkmcnt(8)
  v_mfma_f32_16x16x32_bf16 v[92:95], v[24:27], v[64:67], v[92:95]
  v_mfma_f32_16x16x32_bf16 v[92:95], v[32:35], v[56:59], v[92:95]
  v_mfma_f32_16x16x32_bf16 v[96:99], v[28:31], v[64:67], v[96:99]
  v_mfma_f32_16x16x32_bf16 v[96:99], v[32:35], v[60:63], v[96:99]
  ds_read_b64_tr_b16 v[40:41], v100 offset:2592
  ds_read_b64_tr_b16 v[42:43], v100 offset:2560
  ds_read_b64 v[72:73], v101 offset:640
  ds_read_b64 v[74:75], v101 offset:648
  s_waitcnt lgkmcnt(8)
  v_mfma_f32_16x16x32_bf16 v[84:87], v[20:23], v[60:63], v[84:87]
  v_mfma_f32_16x16x32_bf16 v[84:87], v[28:31], v[52:55], v[84:87]
  v_mfma_f32_16x16x32_bf16 v[88:91], v[20:23], v[64:67], v[88:91]
  v_mfma_f32_16x16x32_bf16 v[88:91], v[32:35], v[52:55], v[88:91]
  v_add_u32 v100, 64, v100
  v_subrev_u32 v101, 16, v101
  ds_read_b64_tr_b16 v[28:29], v100 offset:1056
  ds_read_b64_tr_b16 v[30:31], v100 offset:1024
  ds_read_b64 v[60:61], v101 offset:256
  ds_read_b64 v[62:63], v101 offset:264
  s_waitcnt lgkmcnt(8)
  v_mfma_f32_16x16x32_bf16 v[92:95], v[20:23], v[68:71], v[92:95]
  v_mfma_f32_16x16x32_bf16 v[92:95], v[36:39], v[52:55], v[92:95]
  v_mfma_f32_16x16x32_bf16 v[96:99], v[24:27], v[68:71], v[96:99]
  v_mfma_f32_16x16x32_bf16 v[96:99], v[36:39], v[56:59], v[96:99]
  ds_read_b64_tr_b16 v[24:25], v100 offset:544
  ds_read_b64_tr_b16 v[26:27], v100 offset:512
  ds_read_b64 v[56:57], v101 offset:128
  ds_read_b64 v[58:59], v101 offset:136
  s_waitcnt lgkmcnt(8)
  v_mfma_f32_16x16x32_bf16 v[96:99], v[20:23], v[72:75], v[96:99]
  v_mfma_f32_16x16x32_bf16 v[96:99], v[40:43], v[52:55], v[96:99]
  s_add_u32 s29, s29, 1
  s_cmp_lt_u32 s29, 8
  s_cbranch_scc1 L_cvloop_65
  s_waitcnt lgkmcnt(0)
  s_nop 7
  v_cvt_pk_bf16_f32 v20, v84, v85
  v_cvt_pk_bf16_f32 v21, v86, v87
  v_cvt_pk_bf16_f32 v22, v88, v89
  v_cvt_pk_bf16_f32 v23, v90, v91
  v_cvt_pk_bf16_f32 v24, v92, v93
  v_cvt_pk_bf16_f32 v25, v94, v95
  v_cvt_pk_bf16_f32 v26, v96, v97
  v_cvt_pk_bf16_f32 v27, v98, v99
  s_lshr_b32 s32, s23, 3
  s_lshl_b32 s32, s32, 7
  s_and_b32 s3, s23, 7
  s_lshl_b32 s3, s3, 2
  s_add_u32 s32, s32, s3
  s_add_u32 s32, s32, 14218240
  v_mov_b32 v5, s32
  v_mov_b32 v6, 0x0101
  buffer_store_dwordx4 v[20:23], v102, s[16:19], 0 offen offset:1024 sc1
  buffer_store_dwordx4 v[24:27], v102, s[16:19], 0 offen offset:2048 sc1
  s_mov_b64 exec, 1
  s_waitcnt vmcnt(0)
  global_store_short v5, v6, s[12:13] offset:2 sc1
  s_mov_b64 exec, -1
  s_branch L_phaseY4
L_cvset_59:
  ds_read_b64_tr_b16 v[20:21], v100 offset:32
  ds_read_b64_tr_b16 v[22:23], v100 offset:0
  ds_read_b64 v[52:53], v101 offset:0
  ds_read_b64 v[54:55], v101 offset:8
  ds_read_b64_tr_b16 v[24:25], v100 offset:544
  ds_read_b64_tr_b16 v[26:27], v100 offset:512
  ds_read_b64 v[56:57], v101 offset:128
  ds_read_b64 v[58:59], v101 offset:136
L_cvloop_66:
  ds_read_b64_tr_b16 v[28:29], v100 offset:1056
  ds_read_b64_tr_b16 v[30:31], v100 offset:1024
  ds_read_b64 v[60:61], v101 offset:256
  ds_read_b64 v[62:63], v101 offset:264
  s_waitcnt lgkmcnt(8)
  v_mfma_f32_16x16x32_bf16 v[84:87], v[20:23], v[52:55], v[84:87]
  ds_read_b64_tr_b16 v[32:33], v100 offset:1568
  ds_read_b64_tr_b16 v[34:35], v100 offset:1536
  ds_read_b64 v[64:65], v101 offset:384
  ds_read_b64 v[66:67], v101 offset:392
  s_waitcnt lgkmcnt(8)
  ds_read_b64_tr_b16 v[36:37], v100 offset:2080
  ds_read_b64_tr_b16 v[38:39], v100 offset:2048
  ds_read_b64 v[68:69], v101 offset:512
  ds_read_b64 v[70:71], v101 offset:520
  s_waitcnt lgkmcnt(8)
  ds_read_b64_tr_b16 v[48:49], v100 offset:3616
  ds_read_b64_tr_b16 v[50:51], v100 offset:3584
  ds_read_b64 v[80:81], v101 offset:896
  ds_read_b64 v[82:83], v101 offset:904
  s_waitcnt lgkmcnt(8)
  ds_read_b64_tr_b16 v[44:45], v100 offset:3104
  ds_read_b64_tr_b16 v[46:47], v100 offset:3072
  ds_read_b64 v[76:77], v101 offset:768
  ds_read_b64 v[78:79], v101 offset:776
  s_waitcnt lgkmcnt(8)
  v_mfma_f32_16x16x32_bf16 v[88:91], v[32:35], v[68:71], v[88:91]
  v_mfma_f32_16x16x32_bf16 v[88:91], v[36:39], v[64:67], v[88:91]
  ds_read_b64_tr_b16 v[40:41], v100 offset:2592
  ds_read_b64_tr_b16 v[42:43], v100 offset:2560
  ds_read_b64 v[72:73], v101 offset:640
  ds_read_b64 v[74:75], v101 offset:648
  s_waitcnt lgkmcnt(8)
  v_mfma_f32_16x16x32_bf16 v[88:91], v[20:23], v[80:83], v[88:91]
  v_mfma_f32_16x16x32_bf16 v[88:91], v[48:51], v[52:55], v[88:91]
  v_add_u32 v100, 64, v100
  v_subrev_u32 v101, 16, v101
  ds_read_b64_tr_b16 v[20:21], v100 offset:32
  ds_read_b64_tr_b16 v[22:23], v100 offset:0
  ds_read_b64 v[52:53], v101 offset:0
  ds_read_b64 v[54:55], v101 offset:8
  s_waitcnt lgkmcnt(8)
  v_mfma_f32_16x16x32_bf16 v[88:91], v[24:27], v[76:79], v[88:91]
  v_mfma_f32_16x16x32_bf16 v[88:91], v[44:47], v[56:59], v[88:91]
  ds_read_b64_tr_b16 v[24:25], v100 offset:544
  ds_read_b64_tr_b16 v[26:27], v100 offset:512
  ds_read_b64 v[56:57], v101 offset:128
  ds_read_b64 v[58:59], v101 offset:136
  s_waitcnt lgkmcnt(8)
  v_mfma_f32_16x16x32_bf16 v[88:91], v[28:31], v[72:75], v[88:91]
  v_mfma_f32_16x16x32_bf16 v[88:91], v[40:43], v[60:63], v[88:91]
  s_add_u32 s29, s29, 1
  s_cmp_lt_u32 s29, 8
  s_cbranch_scc1 L_cvloop_66
  s_waitcnt lgkmcnt(0)
  s_nop 7
  v_cvt_pk_bf16_f32 v20, v84, v85
  v_cvt_pk_bf16_f32 v21, v86, v87
  v_cvt_pk_bf16_f32 v22, v88, v89
  v_cvt_pk_bf16_f32 v23, v90, v91
  s_lshr_b32 s32, s23, 3
  s_lshl_b32 s32, s32, 7
  s_and_b32 s3, s23, 7
  s_lshl_b32 s3, s3, 2
  s_add_u32 s32, s32, s3
  s_add_u32 s32, s32, 14218240
  v_mov_b32 v5, s32
  v_mov_b32 v6, 0x0101
  buffer_store_dwordx2 v[20:21], v102, s[16:19], 0 offen offset:0 sc1
  buffer_store_dwordx2 v[22:23], v102, s[16:19], 0 offen offset:3080 sc1
  s_mov_b64 exec, 1
  s_waitcnt vmcnt(0)
  global_store_byte v5, v6, s[12:13] offset:0 sc1
  s_mov_b64 exec, -1
  s_branch L_phaseY
L_cvset_60:
  ds_read_b64_tr_b16 v[20:21], v100 offset:32
  ds_read_b64_tr_b16 v[22:23], v100 offset:0
  ds_read_b64 v[52:53], v101 offset:0
  ds_read_b64 v[54:55], v101 offset:8
  ds_read_b64_tr_b16 v[24:25], v100 offset:544
  ds_read_b64_tr_b16 v[26:27], v100 offset:512
  ds_read_b64 v[56:57], v101 offset:128
  ds_read_b64 v[58:59], v101 offset:136
L_cvloop_67:
  ds_read_b64_tr_b16 v[28:29], v100 offset:1056
  ds_read_b64_tr_b16 v[30:31], v100 offset:1024
  ds_read_b64 v[60:61], v101 offset:256
  ds_read_b64 v[62:63], v101 offset:264
  s_waitcnt lgkmcnt(8)
  ds_read_b64_tr_b16 v[32:33], v100 offset:1568
  ds_read_b64_tr_b16 v[34:35], v100 offset:1536
  ds_read_b64 v[64:65], v101 offset:384
  ds_read_b64 v[66:67], v101 offset:392
  s_waitcnt lgkmcnt(8)
  v_mfma_f32_16x16x32_bf16 v[84:87], v[20:23], v[56:59], v[84:87]
  v_mfma_f32_16x16x32_bf16 v[84:87], v[24:27], v[52:55], v[84:87]
  ds_read_b64_tr_b16 v[44:45], v100 offset:3104
  ds_read_b64_tr_b16 v[46:47], v100 offset:3072
  ds_read_b64 v[76:77], v101 offset:768
  ds_read_b64 v[78:79], v101 offset:776
  s_waitcnt lgkmcnt(8)
  ds_read_b64_tr_b16 v[40:41], v100 offset:2592
  ds_read_b64_tr_b16 v[42:43], v100 offset:2560
  ds_read_b64 v[72:73], v101 offset:640
  ds_read_b64 v[74:75], v101 offset:648
  s_waitcnt lgkmcnt(8)
  v_mfma_f32_16x16x32_bf16 v[88:91], v[32:35], v[64:67], v[88:91]
  ds_read_b64_tr_b16 v[36:37], v100 offset:2080
  ds_read_b64_tr_b16 v[38:39], v100 offset:2048
  ds_read_b64 v[68:69], v101 offset:512
  ds_read_b64 v[70:71], v101 offset:520
  s_waitcnt lgkmcnt(8)
  v_mfma_f32_16x16x32_bf16 v[88:91], v[20:23], v[76:79], v[88:91]
  v_mfma_f32_16x16x32_bf16 v[88:91], v[44:47], v[52:55], v[88:91]
  v_add_u32 v100, 64, v100
  v_subrev_u32 v101, 16, v101
  ds_read_b64_tr_b16 v[20:21], v100 offset:32
  ds_read_b64_tr_b16 v[22:23], v100 offset:0
  ds_read_b64 v[52:53], v101 offset:0
  ds_read_b64 v[54:55], v101 offset:8
  s_waitcnt lgkmcnt(8)
  v_mfma_f32_16x16x32_bf16 v[88:91], v[24:27], v[72:75], v[88:91]
  v_mfma_f32_16x16x32_bf16 v[88:91], v[40:43], v[56:59], v[88:91]
  ds_read_b64_tr_b16 v[24:25], v100 offset:544
  ds_read_b64_tr_b16 v[26:27], v100 offset:512
  ds_read_b64 v[56:57], v101 offset:128
  ds_read_b64 v[58:59], v101 offset:136
  s_waitcnt lgkmcnt(8)
  v_mfma_f32_16x16x32_bf16 v[88:91], v[28:31], v[68:71], v[88:91]
  v_mfma_f32_16x16x32_bf16 v[88:91], v[36:39], v[60:63], v[88:91]
  s_add_u32 s29, s29, 1
  s_cmp_lt_u32 s29, 8
  s_cbranch_scc1 L_cvloop_67
  s_waitcnt lgkmcnt(0)
  s_nop 7
  v_cvt_pk_bf16_f32 v20, v84, v85
  v_cvt_pk_bf16_f32 v21, v86, v87
  v_cvt_pk_bf16_f32 v22, v88, v89
  v_cvt_pk_bf16_f32 v23, v90, v91
  s_lshr_b32 s32, s23, 3
  s_lshl_b32 s32, s32, 7
  s_and_b32 s3, s23, 7
  s_lshl_b32 s3, s3, 2
  s_add_u32 s32, s32, s3
  s_add_u32 s32, s32, 14218240
  v_mov_b32 v5, s32
  v_mov_b32 v6, 0x0101
  buffer_store_dwordx2 v[20:21], v102, s[16:19], 0 offen offset:8 sc1
  buffer_store_dwordx2 v[22:23], v102, s[16:19], 0 offen offset:3072 sc1
  s_mov_b64 exec, 1
  s_waitcnt vmcnt(0)
  global_store_byte v5, v6, s[12:13] offset:1 sc1
  s_mov_b64 exec, -1
  s_branch L_phaseY
L_cvset_61:
  ds_read_b64_tr_b16 v[20:21], v100 offset:32
  ds_read_b64_tr_b16 v[22:23], v100 offset:0
  ds_read_b64 v[52:53], v101 offset:0
  ds_read_b64 v[54:55], v101 offset:8
  ds_read_b64_tr_b16 v[24:25], v100 offset:544
  ds_read_b64_tr_b16 v[26:27], v100 offset:512
  ds_read_b64 v[56:57], v101 offset:128
  ds_read_b64 v[58:59], v101 offset:136
L_cvloop_68:
  ds_read_b64_tr_b16 v[28:29], v100 offset:1056
  ds_read_b64_tr_b16 v[30:31], v100 offset:1024
  ds_read_b64 v[60:61], v101 offset:256
  ds_read_b64 v[62:63], v101 offset:264
  s_waitcnt lgkmcnt(8)
  ds_read_b64_tr_b16 v[40:41], v100 offset:2592
  ds_read_b64_tr_b16 v[42:43], v100 offset:2560
  ds_read_b64 v[72:73], v101 offset:640
  ds_read_b64 v[74:75], v101 offset:648
  s_waitcnt lgkmcnt(8)
  v_mfma_f32_16x16x32_bf16 v[84:87], v[24:27], v[56:59], v[84:87]
  ds_read_b64_tr_b16 v[36:37], v100 offset:2080
  ds_read_b64_tr_b16 v[38:39], v100 offset:2048
  ds_read_b64 v[68:69], v101 offset:512
  ds_read_b64 v[70:71], v101 offset:520
  s_waitcnt lgkmcnt(8)
  v_mfma_f32_16x16x32_bf16 v[84:87], v[20:23], v[60:63], v[84:87]
  v_mfma_f32_16x16x32_bf16 v[84:87], v[28:31], v[52:55], v[84:87]
  ds_read_b64_tr_b16 v[32:33], v100 offset:1568
  ds_read_b64_tr_b16 v[34:35], v100 offset:1536
  ds_read_b64 v[64:65], v101 offset:384
  ds_read_b64 v[66:67], v101 offset:392
  s_waitcnt lgkmcnt(8)
  v_mfma_f32_16x16x32_bf16 v[88:91], v[20:23], v[72:75], v[88:91]
  v_mfma_f32_16x16x32_bf16 v[88:91], v[40:43], v[52:55], v[88:91]
  v_add_u32 v100, 64, v100
  v_subrev_u32 v101, 16, v101
  ds_read_b64_tr_b16 v[20:21], v100 offset:32
  ds_read_b64_tr_b16 v[22:23], v100 offset:0
  ds_read_b64 v[52:53], v101 offset:0
  ds_read_b64 v[54:55], v101 offset:8
  s_waitcnt lgkmcnt(8)
  v_mfma_f32_16x16x32_bf16 v[88:91], v[24:27], v[68:71], v[88:91]
  v_mfma_f32_16x16x32_bf16 v[88:91], v[36:39], v[56:59], v[88:91]
  ds_read_b64_tr_b16 v[24:25], v100 offset:544
  ds_read_b64_tr_b16 v[26:27], v100 offset:512
  ds_read_b64 v[56:57], v101 offset:128
  ds_read_b64 v[58:59], v101 offset:136
  s_waitcnt lgkmcnt(8)
  v_mfma_f32_16x16x32_bf16 v[88:91], v[28:31], v[64:67], v[88:91]
  v_mfma_f32_16x16x32_bf16 v[88:91], v[32:35], v[60:63], v[88:91]
  s_add_u32 s29, s29, 1
  s_cmp_lt_u32 s29, 8
  s_cbranch_scc1 L_cvloop_68
  s_waitcnt lgkmcnt(0)
  s_nop 7
  v_cvt_pk_bf16_f32 v20, v84, v85
  v_cvt_pk_bf16_f32 v21, v86, v87
  v_cvt_pk_bf16_f32 v22, v88, v89
  v_cvt_pk_bf16_f32 v23, v90, v91
  s_lshr_b32 s32, s23, 3
  s_lshl_b32 s32, s32, 7
  s_and_b32 s3, s23, 7
  s_lshl_b32 s3, s3, 2
  s_add_u32 s32, s32, s3
  s_add_u32 s32, s32, 14218240
  v_mov_b32 v5, s32
  v_mov_b32 v6, 0x0101
  buffer_store_dwordx2 v[20:21], v102, s[16:19], 0 offen offset:1024 sc1
  buffer_store_dwordx2 v[22:23], v102, s[16:19], 0 offen offset:2056 sc1
  s_mov_b64 exec, 1
  s_waitcnt vmcnt(0)
  global_store_byte v5, v6, s[12:13] offset:2 sc1
  s_mov_b64 exec, -1
  s_branch L_phaseY
L_cvset_62:
  ds_read_b64_tr_b16 v[28:29], v100 offset:1056
  ds_read_b64_tr_b16 v[30:31], v100 offset:1024
  ds_read_b64 v[60:61], v101 offset:256
  ds_read_b64 v[62:63], v101 offset:264
  ds_read_b64_tr_b16 v[24:25], v100 offset:544
  ds_read_b64_tr_b16 v[26:27], v100 offset:512
  ds_read_b64 v[56:57], v101 offset:128
  ds_read_b64 v[58:59], v101 offset:136
L_cvloop_69:
  ds_read_b64_tr_b16 v[32:33], v100 offset:1568
  ds_read_b64_tr_b16 v[34:35], v100 offset:1536
  ds_read_b64 v[64:65], v101 offset:384
  ds_read_b64 v[66:67], v101 offset:392
  s_waitcnt lgkmcnt(8)
  v_mfma_f32_16x16x32_bf16 v[88:91], v[28:31], v[60:63], v[88:91]
  ds_read_b64_tr_b16 v[20:21], v100 offset:32
  ds_read_b64_tr_b16 v[22:23], v100 offset:0
  ds_read_b64 v[52:53], v101 offset:0
  ds_read_b64 v[54:55], v101 offset:8
  s_waitcnt lgkmcnt(8)
  v_mfma_f32_16x16x32_bf16 v[84:87], v[24:27], v[60:63], v[84:87]
  v_mfma_f32_16x16x32_bf16 v[84:87], v[28:31], v[56:59], v[84:87]
  ds_read_b64_tr_b16 v[36:37], v100 offset:2080
  ds_read_b64_tr_b16 v[38:39], v100 offset:2048
  ds_read_b64 v[68:69], v101 offset:512
  ds_read_b64 v[70:71], v101 offset:520
  s_waitcnt lgkmcnt(8)
  v_mfma_f32_16x16x32_bf16 v[88:91], v[24:27], v[64:67], v[88:91]
  v_mfma_f32_16x16x32_bf16 v[88:91], v[32:35], v[56:59], v[88:91]
  v_add_u32 v100, 64, v100
  v_subrev_u32 v101, 16, v101
  ds_read_b64_tr_b16 v[28:29], v100 offset:1056
  ds_read_b64_tr_b16 v[30:31], v100 offset:1024
  ds_read_b64 v[60:61], v101 offset:256
  ds_read_b64 v[62:63], v101 offset:264
  s_waitcnt lgkmcnt(8)
  v_mfma_f32_16x16x32_bf16 v[84:87], v[20:23], v[64:67], v[84:87]
  v_mfma_f32_16x16x32_bf16 v[84:87], v[32:35], v[52:55], v[84:87]
  ds_read_b64_tr_b16 v[24:25], v100 offset:544
  ds_read_b64_tr_b16 v[26:27], v100 offset:512
  ds_read_b64 v[56:57], v101 offset:128
  ds_read_b64 v[58:59], v101 offset:136
  s_waitcnt lgkmcnt(8)
  v_mfma_f32_16x16x32_bf16 v[88:91], v[20:23], v[68:71], v[88:91]
  v_mfma_f32_16x16x32_bf16 v[88:91], v[36:39], v[52:55], v[88:91]
  s_add_u32 s29, s29, 1
  s_cmp_lt_u32 s29, 8
  s_cbranch_scc1 L_cvloop_69
  s_waitcnt lgkmcnt(0)
  s_nop 7
  v_cvt_pk_bf16_f32 v20, v84, v85
  v_cvt_pk_bf16_f32 v21, v86, v87
  v_cvt_pk_bf16_f32 v22, v88, v89
  v_cvt_pk_bf16_f32 v23, v90, v91
  s_lshr_b32 s32, s23, 3
  s_lshl_b32 s32, s32, 7
  s_and_b32 s3, s23, 7
  s_lshl_b32 s3, s3, 2
  s_add_u32 s32, s32, s3
  s_add_u32 s32, s32, 14218240
  v_mov_b32 v5, s32
  v_mov_b32 v6, 0x0101
  buffer_store_dwordx2 v[20:21], v102, s[16:19], 0 offen offset:1032 sc1
  buffer_store_dwordx2 v[22:23], v102, s[16:19], 0 offen offset:2048 sc1
  s_mov_b64 exec, 1
  s_waitcnt vmcnt(0)
  global_store_byte v5, v6, s[12:13] offset:3 sc1
  s_mov_b64 exec, -1
  s_branch L_phaseY
L_phaseY:
  s_cmp_ge_u32 s36, 144
  s_cbranch_scc1 L_ydone
  s_setprio 0
  s_lshl_b32 s32, s38, 10
  s_add_u32 s32, s32, 14218240
  v_lshrrev_b32 v5, 3, v2
  v_lshlrev_b32 v5, 7, v5
  v_and_b32 v6, 7, v2
  v_lshl_add_u32 v5, v6, 2, v5
  v_add_u32 v5, s32, v5
  v_mov_b32 v7, 0x01010101
  s_mov_b32 s31, 0x10000
L_pl_70:
  global_load_dword v6, v5, s[12:13] sc1
  s_waitcnt vmcnt(0)
  v_cmp_ne_u32 vcc, v7, v6
  s_sub_u32 s31, s31, 1
  s_cbranch_scc1 L_pd_71
  s_nop 2
  s_cmp_eq_u64 vcc, 0
  s_cbranch_scc1 L_pd_71
  s_sleep 16
  s_branch L_pl_70
L_pd_71:
  s_barrier
  s_branch L_ydone
L_phaseY4:
  s_sub_u32 s36, s2, 336
  s_sub_u32 s3, s2, 368
  s_cmp_ge_u32 s2, 416
  s_cselect_b32 s36, s3, s36
  s_sub_u32 s3, s2, 384
  s_cmp_lt_u32 s3, 32
  s_cselect_b32 s36, -1, s36
  s_cmp_ge_u32 s36, 144
  s_cbranch_scc1 L_ydone
  s_mov_b32 s3, s36
  s_mul_i32 s37, s3, 7282
  s_lshr_b32 s37, s37, 16
  s_mul_i32 s38, s37, 9
  s_sub_u32 s38, s3, s38
  v_and_b32 v7, 3, v2
  v_xor_b32 v100, v7, v104
  v_lshlrev_b32 v100, 4, v100
  v_lshrrev_b32 v19, 2, v103
  v_lshl_add_u32 v100, v19, 8, v100
  v_lshl_add_u32 v100, v104, 12, v100
  s_lshl_b32 s33, s38, 18
  s_lshr_b32 s31, s37, 2
  s_lshl_b32 s31, s31, 10
  s_add_u32 s33, s33, s31
  s_and_b32 s31, s37, 3
  s_lshl_b32 s31, s31, 6
  s_add_u32 s33, s33, s31
  s_lshl_b32 s31, s20, 16
  s_add_u32 s33, s33, s31
  s_add_u32 s33, s33, 10485760
  s_lshl_b32 s34, s20, 12
  v_add_u32 v17, s34, v4
  v_lshrrev_b32 v12, 1, v104
  v_xor_b32 v12, v12, v19
  v_lshlrev_b32 v12, 4, v12
  v_lshl_add_u32 v12, v19, 8, v12
  v_lshl_add_u32 v12, v7, 6, v12
  v_and_b32 v5, 1, v104
  v_lshl_add_u32 v12, v5, 3, v12
  v_add_u32 v12, s34, v12
  v_xor_b32 v13, 32, v12
  v_lshlrev_b32 v14, 6, v5
  v_add_u32 v14, v14, v103
  v_lshrrev_b32 v5, 1, v104
  v_lshl_add_u32 v14, v5, 4, v14
  v_mul_u32_u24 v14, 144, v14
  s_lshl_b32 s31, s20, 5
  v_add_u32 v14, s31, v14
  v_lshrrev_b32 v5, 3, v2
  v_and_b32 v6, 7, v2
  v_mul_u32_u24 v16, 2304, v5
  v_lshl_add_u32 v16, v6, 4, v16
  v_mul_u32_u24 v15, 144, v5
  v_lshl_add_u32 v15, v6, 4, v15
  s_mul_i32 s31, s20, 4608
  v_add_u32 v15, s31, v15
  s_lshr_b32 s3, s37, 2
  s_lshl_b32 s3, s3, 9
  s_and_b32 s31, s37, 3
  s_lshl_b32 s31, s31, 6
  s_add_u32 s3, s3, s31
  s_lshr_b32 s31, s20, 1
  s_lshl_b32 s31, s31, 8
  s_add_u32 s3, s3, s31
  s_and_b32 s31, s20, 1
  s_lshl_b32 s31, s31, 5
  s_add_u32 s3, s3, s31
  s_mul_i32 s3, s3, 2304
  s_lshl_b32 s31, s38, 7
  s_add_u32 s3, s3, s31
  s_barrier
  s_setprio 2
  s_add_u32 s30, s33, 0
  buffer_load_dwordx4 v[20:23], v100, s[16:19], s30 offen sc1
  s_add_u32 s30, s33, 16384
  buffer_load_dwordx4 v[24:27], v100, s[16:19], s30 offen sc1
  s_add_u32 s30, s33, 32768
  buffer_load_dwordx4 v[28:31], v100, s[16:19], s30 offen sc1
  s_add_u32 s30, s33, 49152
  buffer_load_dwordx4 v[32:35], v100, s[16:19], s30 offen sc1
  s_waitcnt vmcnt(3)
  ds_write_b128 v17, v[20:23] offset:0
  s_waitcnt vmcnt(2)
  ds_write_b128 v17, v[24:27] offset:1024
  s_waitcnt vmcnt(1)
  ds_write_b128 v17, v[28:31] offset:2048
  s_waitcnt vmcnt(0)
  ds_write_b128 v17, v[32:35] offset:3072
  s_waitcnt lgkmcnt(0)
  ds_read_b64_tr_b16 v[20:21], v12 offset:0
  ds_read_b64_tr_b16 v[22:23], v13 offset:0
  ds_read_b64_tr_b16 v[24:25], v12 offset:1024
  ds_read_b64_tr_b16 v[26:27], v13 offset:1024
  ds_read_b64_tr_b16 v[28:29], v12 offset:2048
  ds_read_b64_tr_b16 v[30:31], v13 offset:2048
  ds_read_b64_tr_b16 v[32:33], v12 offset:3072
  ds_read_b64_tr_b16 v[34:35], v13 offset:3072
  s_waitcnt lgkmcnt(0)
  ds_write_b64 v14, v[20:21] offset:16384
  ds_write_b64 v14, v[22:23] offset:20992
  ds_write_b64 v14, v[24:25] offset:16392
  ds_write_b64 v14, v[26:27] offset:21000
  ds_write_b64 v14, v[28:29] offset:16400
  ds_write_b64 v14, v[30:31] offset:21008
  ds_write_b64 v14, v[32:33] offset:16408
  ds_write_b64 v14, v[34:35] offset:21016
  s_waitcnt lgkmcnt(0)
  s_barrier
  ds_read_b128 v[20:23], v15 offset:16384
  ds_read_b128 v[24:27], v15 offset:17536
  ds_read_b128 v[28:31], v15 offset:18688
  ds_read_b128 v[32:35], v15 offset:19840
  s_add_u32 s30, s3, 0
  s_waitcnt lgkmcnt(3)
  buffer_store_dwordx4 v[20:23], v16, s[4:7], s30 offen sc1
  s_add_u32 s30, s3, 18432
  s_waitcnt lgkmcnt(2)
  buffer_store_dwordx4 v[24:27], v16, s[4:7], s30 offen sc1
  s_add_u32 s30, s3, 36864
  s_waitcnt lgkmcnt(1)
  buffer_store_dwordx4 v[28:31], v16, s[4:7], s30 offen sc1
  s_add_u32 s30, s3, 55296
  s_waitcnt lgkmcnt(0)
  buffer_store_dwordx4 v[32:35], v16, s[4:7], s30 offen sc1
L_ydone:
  s_endpgm
L_end_k2_kernel:
  s_endpgm
.section .rodata,"a"
.p2align 6
.amdhsa_kernel k2_kernel
  .amdhsa_next_free_vgpr 127
  .amdhsa_next_free_sgpr 96
  .amdhsa_accum_offset 128
  .amdhsa_group_segment_fixed_size 0
  .amdhsa_kernarg_size 136
  .amdhsa_user_sgpr_count 2
  .amdhsa_user_sgpr_kernarg_segment_ptr 1
  .amdhsa_system_sgpr_workgroup_id_x 1
.end_amdhsa_kernel
```
